```python
import torch

def _softmax(x, axis=-1):
    return torch.softmax(x, dim=axis)

def _gelu(x):
    return torch.nn.functional.gelu(x, approximate='tanh')

def _silu(x):
    return torch.nn.functional.silu(x)

def _sigmoid(x):
    return torch.sigmoid(x)

def _layernorm(x, axis=-1, eps=1e-05):
    m = x.mean(dim=axis, keepdim=True)
    v = x.var(dim=axis, keepdim=True, unbiased=False)
    return (x - m) / torch.sqrt(v + eps)

def _scatter_add(tgt, idx, src, axis=0):
    return tgt.clone().index_add_(axis, idx, src)

def _segment_sum(src, seg, n):
    out = torch.zeros((n,) + src.shape[1:], dtype=src.dtype)
    return out.index_add_(0, seg, src)

def _pad(x, pw):
    flat = tuple((v for pair in reversed(pw) for v in pair))
    return torch.nn.functional.pad(x, flat)
kernel_name = 'adaLN_cond__ssm_conv_h3__dense_activation_relu__prompt'

def setup_inputs():

    _w = lambda a: (lambda t: t.to(torch.bfloat16) if t.is_floating_point() else t)(torch.as_tensor(a))

    def _A_setup():
        B, S, D = (1, 2048, 512)
        ks = 4
        return {'q': _w((lambda *s: torch.randn(*s, dtype=torch.bfloat16) * 0.05)(B, S, D)), 'k': _w((lambda *s: torch.randn(*s, dtype=torch.bfloat16) * 0.8)(B, S, D)), 'v': _w((lambda *s: torch.randn(*s, dtype=torch.bfloat16) * 0.8)(B, S, D)), 'shift_k': _w((lambda *s: torch.randn(*s, dtype=torch.bfloat16) * 0.8)(D, ks) * 0.5), 'ssm_k': _w((lambda *s: torch.randn(*s, dtype=torch.bfloat16) * 0.8)(D, S) * (1.0 / S ** 0.5)), 'ssm_D': _w((lambda *s: torch.randn(*s, dtype=torch.bfloat16) * 0.8)(D))}
    _A_in = _A_setup()

    def _B_setup():
        B, S, D, Dff = (1, 2048, 512, 1792)
        return {'x': _w((lambda *s: torch.randn(*s, dtype=torch.bfloat16) * 0.05)(B, S, D)), 'w1': _w((lambda *s: torch.randn(*s, dtype=torch.bfloat16) * 0.05)(D, Dff)), 'w2': _w((lambda *s: torch.randn(*s, dtype=torch.bfloat16) * 0.05)(Dff, D))}
    _B_in = _B_setup()
    return {'A_q': _A_in['q'], 'A_k': _A_in['k'], 'A_v': _A_in['v'], 'A_shift_k': _A_in['shift_k'], 'A_ssm_k': _A_in['ssm_k'], 'A_ssm_D': _A_in['ssm_D'], 'B_x': _B_in['x'], 'B_w1': _B_in['w1'], 'B_w2': _B_in['w2'], 'c': _w((lambda *s: torch.randn(*s, dtype=torch.bfloat16) * 0.2)(1, 512) * 8.0), 'w_mod': _w((lambda *s: torch.randn(*s, dtype=torch.bfloat16) * 0.2)(512, 6 * 512) * 512 ** (-0.5) * 8.0)}

def reference(A_q, A_k, A_v, A_shift_k, A_ssm_k, A_ssm_D, B_x, B_w1, B_w2, c, w_mod):

    def _A_ref(q, k, v, shift_k, ssm_k, ssm_D):
        B, S, D = q.shape
        ks = shift_k.shape[-1]
        k_pad = _pad(k, ((0, 0), (ks - 1, 0), (0, 0)))
        k_shift = torch.zeros_like(k)
        for t in range(ks):
            k_shift = k_shift + k_pad[:, t:t + S, :] * shift_k[:, ks - 1 - t][None, None, :]
        kv = k_shift * v
        L = 2 * S
        kv_pad = _pad(kv, ((0, 0), (0, S), (0, 0)))
        kf_pad = _pad(ssm_k, ((0, 0), (0, S)))
        kv_f = (lambda x, axes=(-2, -1): torch.fft.rfft2(x.float(), dim=axes))(kv_pad[:, None, :, :], axes=(1, 2))
        kf_f = (lambda x, axes=(-2, -1): torch.fft.rfft2(x.float(), dim=axes))(kf_pad[:, None, :], axes=(1, 2))
        kf_f = (lambda x, *d: x.permute(*d))(kf_f, 1, 2, 0)
        y_f = kv_f * kf_f[None, :, :, :]
        y = (lambda x, s, axes=(-2, -1): torch.fft.irfft2(x, s=s, dim=axes).to(torch.bfloat16))(y_f, (1, L), axes=(1, 2))[:, 0, :S, :]
        y = y + kv * ssm_D[None, None, :]
        return q * y

    def _B_ref(x, w1, w2):
        h = torch.einsum('bsd,df->bsf', x, w1)
        zero = torch.zeros_like(h)
        h = torch.maximum(h, zero)
        return torch.einsum('bsf,fd->bsd', h, w2)
    x = A_q
    mod = (_silu(c) @ w_mod).reshape(c.shape[0], 6, 1, -1)
    sa, ca, ga, sb, cb, gb = (mod[:, 0].clone(), mod[:, 1].clone(), mod[:, 2].clone(), mod[:, 3].clone(), mod[:, 4].clone(), mod[:, 5].clone())
    h = _layernorm(x, axis=-1) * (1 + ca) + sa
    x = x + ga * _A_ref(h, A_k, A_v, A_shift_k, A_ssm_k, A_ssm_D)
    h = _layernorm(x, axis=-1) * (1 + cb) + sb
    x = x + gb * _B_ref(h, B_w1, B_w2)
    return x
```

```asm
; @launch grid=(256,1,1) block=(512,1,1) lds=159744
.amdgcn_target "amdgcn-amd-amdhsa--gfx950"
.text
.globl adaLN_cond__ssm_conv_h3__dense_activation_relu__prompt_kernel
.p2align 8
.type adaLN_cond__ssm_conv_h3__dense_activation_relu__prompt_kernel,@function
adaLN_cond__ssm_conv_h3__dense_activation_relu__prompt_kernel:
    s_cmp_ge_u32 s2, 256
    s_cbranch_scc1 F_END
    s_load_dwordx2 s[4:5], s[0:1], 104
    s_load_dwordx2 s[70:71], s[0:1], 96
    v_lshrrev_b32 v1, 6, v0
    v_and_b32 v0, 63, v0
    s_nop 0
    v_readfirstlane_b32 s3, v1
    s_nop 1
    s_load_dwordx4 s[8:11], s[0:1], 0
    s_cmp_ge_u32 s3, 4
    s_cbranch_scc1 PA_AUX
    s_load_dwordx4 s[12:15], s[0:1], 16
    s_and_b32 s16, s2, 7
    s_lshr_b32 s17, s2, 3
    v_and_b32 v1, 31, v0
    v_lshrrev_b32 v2, 5, v0
    s_lshl_b32 s18, s3, 1
    v_add_u32 v2, s18, v2
    s_lshl_b32 s18, s17, 6
    v_lshlrev_b32 v3, 3, v2
    v_add_u32 v3, s18, v3
    s_lshl_b32 s18, s16, 6
    v_lshlrev_b32 v4, 1, v1
    v_add_u32 v4, s18, v4
    v_lshlrev_b32 v5, 10, v3
    v_lshl_add_u32 v5, v4, 1, v5
    v_subrev_u32 v6, 3072, v5
    v_lshlrev_b32 v7, 3, v4
    s_movk_i32 s18, 0x1000
    s_waitcnt lgkmcnt(0)
    s_mov_b32 s20, s8
    s_mov_b32 s21, s9
    s_mov_b32 s22, 0x200000
    s_mov_b32 s23, 0x20000
    buffer_load_dword v32, v5, s[20:23], 0 offen offset:0
    buffer_load_dword v33, v5, s[20:23], 0 offen offset:1024
    buffer_load_dword v34, v5, s[20:23], 0 offen offset:2048
    buffer_load_dword v35, v5, s[20:23], 0 offen offset:3072
    buffer_load_dword v36, v5, s[20:23], s18 offen offset:0
    buffer_load_dword v37, v5, s[20:23], s18 offen offset:1024
    buffer_load_dword v38, v5, s[20:23], s18 offen offset:2048
    buffer_load_dword v39, v5, s[20:23], s18 offen offset:3072
    s_mov_b32 s32, s14
    s_mov_b32 s33, s15
    s_mov_b32 s34, 0x1000
    s_mov_b32 s35, 0x20000
    buffer_load_dwordx4 v[40:43], v7, s[32:35], 0 offen
    s_mov_b32 s24, s10
    s_mov_b32 s25, s11
    s_mov_b32 s26, 0x200000
    s_mov_b32 s27, 0x20000
    buffer_load_dword v10, v6, s[24:27], 0 offen offset:0
    buffer_load_dword v11, v6, s[24:27], 0 offen offset:1024
    buffer_load_dword v12, v6, s[24:27], 0 offen offset:2048
    buffer_load_dword v13, v5, s[24:27], 0 offen offset:0
    buffer_load_dword v14, v5, s[24:27], 0 offen offset:1024
    buffer_load_dword v15, v5, s[24:27], 0 offen offset:2048
    buffer_load_dword v16, v5, s[24:27], 0 offen offset:3072
    buffer_load_dword v17, v5, s[24:27], s18 offen offset:0
    buffer_load_dword v18, v5, s[24:27], s18 offen offset:1024
    buffer_load_dword v19, v5, s[24:27], s18 offen offset:2048
    buffer_load_dword v20, v5, s[24:27], s18 offen offset:3072
    s_mov_b32 s28, s12
    s_mov_b32 s29, s13
    s_mov_b32 s30, 0x200000
    s_mov_b32 s31, 0x20000
    buffer_load_dword v22, v5, s[28:31], 0 offen offset:0
    buffer_load_dword v23, v5, s[28:31], 0 offen offset:1024
    buffer_load_dword v24, v5, s[28:31], 0 offen offset:2048
    buffer_load_dword v25, v5, s[28:31], 0 offen offset:3072
    buffer_load_dword v26, v5, s[28:31], s18 offen offset:0
    buffer_load_dword v27, v5, s[28:31], s18 offen offset:1024
    buffer_load_dword v28, v5, s[28:31], s18 offen offset:2048
    buffer_load_dword v29, v5, s[28:31], s18 offen offset:3072
    s_mov_b32 s60, s70
    s_mov_b32 s61, s71
    s_mov_b32 s62, 0x100
    s_mov_b32 s63, 0x20000
    s_add_u32 s64, s4, 0x438000
    s_addc_u32 s65, s5, 0
    s_mov_b32 s66, 0x4000
    s_mov_b32 s67, 0x20000
    v_mov_b32 v250, 0
    v_lshlrev_b32 v251, 2, v0
    v_add_u32 v251, 76800, v251
    s_mov_b64 exec, 0xffff
    ds_write_b32 v251, v250
    s_mov_b64 exec, -1
    s_waitcnt lgkmcnt(0)
    s_barrier
    s_mov_b32 s36, s4
    s_mov_b32 s37, s5
    s_mov_b32 s38, 0x200000
    s_mov_b32 s39, 0x20000
    s_add_u32 s40, s4, 0x200000
    s_addc_u32 s41, s5, 0
    s_mov_b32 s42, 0x200000
    s_mov_b32 s43, 0x20000
    v_and_b32 v8, 7, v1
    v_xor_b32 v9, v2, v8
    v_lshlrev_b32 v44, 8, v1
    v_lshl_add_u32 v45, v9, 4, v44
    v_add_u32 v45, 20480, v45
    v_xor_b32 v9, 7, v9
    v_lshl_add_u32 v44, v9, 4, v44
    v_add_u32 v44, 28672, v44
    v_lshrrev_b32 v96, 3, v0
    s_lshl_b32 s45, s3, 4
    v_add_u32 v96, s45, v96
    v_and_b32 v97, 7, v0
    v_bfe_u32 v98, v96, 1, 3
    v_xor_b32 v98, v97, v98
    v_lshlrev_b32 v98, 4, v98
    v_lshl_add_u32 v98, v96, 7, v98
    v_xor_b32 v99, 64, v98
    v_add_u32 v99, 1024, v99
    s_lshl_b32 s45, s16, 6
    v_add_u32 v96, s45, v96
    v_lshlrev_b32 v96, 12, v96
    v_lshl_add_u32 v96, v97, 4, v96
    s_lshl_b32 s46, s17, 7
    s_sub_u32 s47, 3968, s46
    s_add_u32 s48, s46, 32768
    s_add_u32 s49, s47, 32768
    s_mov_b32 s19, 0x05040100
    s_mov_b32 s44, 0x07060302
    s_waitcnt vmcnt(20)
    v_perm_b32 v88, v33, v32, s19
    v_perm_b32 v89, v35, v34, s19
    v_perm_b32 v90, v37, v36, s19
    v_perm_b32 v91, v39, v38, s19
    v_perm_b32 v92, v33, v32, s44
    v_perm_b32 v93, v35, v34, s44
    v_perm_b32 v94, v37, v36, s44
    v_perm_b32 v95, v39, v38, s44
    ds_write_b128 v45, v[88:91]
    ds_write_b128 v45, v[92:95] offset:128
    s_waitcnt vmcnt(0)
    v_lshlrev_b32 v46, 16, v40
    v_and_b32 v47, 0xffff0000, v40
    v_lshlrev_b32 v48, 16, v41
    v_and_b32 v49, 0xffff0000, v41
    v_lshlrev_b32 v50, 16, v42
    v_and_b32 v51, 0xffff0000, v42
    v_lshlrev_b32 v52, 16, v43
    v_and_b32 v53, 0xffff0000, v43
    v_lshlrev_b32 v60, 16, v10
    v_lshlrev_b32 v61, 16, v11
    v_lshlrev_b32 v62, 16, v12
    v_lshlrev_b32 v63, 16, v13
    v_lshlrev_b32 v64, 16, v14
    v_lshlrev_b32 v65, 16, v15
    v_lshlrev_b32 v66, 16, v16
    v_lshlrev_b32 v67, 16, v17
    v_lshlrev_b32 v68, 16, v18
    v_lshlrev_b32 v69, 16, v19
    v_lshlrev_b32 v70, 16, v20
    v_mul_f32 v72, v63, v46
    v_mul_f32 v73, v64, v46
    v_mul_f32 v74, v65, v46
    v_mul_f32 v75, v66, v46
    v_mul_f32 v76, v67, v46
    v_mul_f32 v77, v68, v46
    v_mul_f32 v78, v69, v46
    v_mul_f32 v79, v70, v46
    v_fmac_f32 v72, v62, v47
    v_fmac_f32 v73, v63, v47
    v_fmac_f32 v74, v64, v47
    v_fmac_f32 v75, v65, v47
    v_fmac_f32 v76, v66, v47
    v_fmac_f32 v77, v67, v47
    v_fmac_f32 v78, v68, v47
    v_fmac_f32 v79, v69, v47
    v_fmac_f32 v72, v61, v48
    v_fmac_f32 v73, v62, v48
    v_fmac_f32 v74, v63, v48
    v_fmac_f32 v75, v64, v48
    v_fmac_f32 v76, v65, v48
    v_fmac_f32 v77, v66, v48
    v_fmac_f32 v78, v67, v48
    v_fmac_f32 v79, v68, v48
    v_fmac_f32 v72, v60, v49
    v_fmac_f32 v73, v61, v49
    v_fmac_f32 v74, v62, v49
    v_fmac_f32 v75, v63, v49
    v_fmac_f32 v76, v64, v49
    v_fmac_f32 v77, v65, v49
    v_fmac_f32 v78, v66, v49
    v_fmac_f32 v79, v67, v49
    v_lshlrev_b32 v60, 16, v22
    v_lshlrev_b32 v61, 16, v23
    v_lshlrev_b32 v62, 16, v24
    v_lshlrev_b32 v63, 16, v25
    v_lshlrev_b32 v64, 16, v26
    v_lshlrev_b32 v65, 16, v27
    v_lshlrev_b32 v66, 16, v28
    v_lshlrev_b32 v67, 16, v29
    v_mul_f32 v72, v72, v60
    v_mul_f32 v73, v73, v61
    v_mul_f32 v74, v74, v62
    v_mul_f32 v75, v75, v63
    v_mul_f32 v76, v76, v64
    v_mul_f32 v77, v77, v65
    v_mul_f32 v78, v78, v66
    v_mul_f32 v79, v79, v67
    v_cvt_pk_bf16_f32 v80, v79, v78
    v_cvt_pk_bf16_f32 v81, v77, v76
    v_cvt_pk_bf16_f32 v82, v75, v74
    v_cvt_pk_bf16_f32 v83, v73, v72
    ds_write_b128 v44, v[80:83] offset:0
    v_and_b32 v60, 0xffff0000, v10
    v_and_b32 v61, 0xffff0000, v11
    v_and_b32 v62, 0xffff0000, v12
    v_and_b32 v63, 0xffff0000, v13
    v_and_b32 v64, 0xffff0000, v14
    v_and_b32 v65, 0xffff0000, v15
    v_and_b32 v66, 0xffff0000, v16
    v_and_b32 v67, 0xffff0000, v17
    v_and_b32 v68, 0xffff0000, v18
    v_and_b32 v69, 0xffff0000, v19
    v_and_b32 v70, 0xffff0000, v20
    v_mul_f32 v72, v63, v50
    v_mul_f32 v73, v64, v50
    v_mul_f32 v74, v65, v50
    v_mul_f32 v75, v66, v50
    v_mul_f32 v76, v67, v50
    v_mul_f32 v77, v68, v50
    v_mul_f32 v78, v69, v50
    v_mul_f32 v79, v70, v50
    v_fmac_f32 v72, v62, v51
    v_fmac_f32 v73, v63, v51
    v_fmac_f32 v74, v64, v51
    v_fmac_f32 v75, v65, v51
    v_fmac_f32 v76, v66, v51
    v_fmac_f32 v77, v67, v51
    v_fmac_f32 v78, v68, v51
    v_fmac_f32 v79, v69, v51
    v_fmac_f32 v72, v61, v52
    v_fmac_f32 v73, v62, v52
    v_fmac_f32 v74, v63, v52
    v_fmac_f32 v75, v64, v52
    v_fmac_f32 v76, v65, v52
    v_fmac_f32 v77, v66, v52
    v_fmac_f32 v78, v67, v52
    v_fmac_f32 v79, v68, v52
    v_fmac_f32 v72, v60, v53
    v_fmac_f32 v73, v61, v53
    v_fmac_f32 v74, v62, v53
    v_fmac_f32 v75, v63, v53
    v_fmac_f32 v76, v64, v53
    v_fmac_f32 v77, v65, v53
    v_fmac_f32 v78, v66, v53
    v_fmac_f32 v79, v67, v53
    v_and_b32 v60, 0xffff0000, v22
    v_and_b32 v61, 0xffff0000, v23
    v_and_b32 v62, 0xffff0000, v24
    v_and_b32 v63, 0xffff0000, v25
    v_and_b32 v64, 0xffff0000, v26
    v_and_b32 v65, 0xffff0000, v27
    v_and_b32 v66, 0xffff0000, v28
    v_and_b32 v67, 0xffff0000, v29
    v_mul_f32 v72, v72, v60
    v_mul_f32 v73, v73, v61
    v_mul_f32 v74, v74, v62
    v_mul_f32 v75, v75, v63
    v_mul_f32 v76, v76, v64
    v_mul_f32 v77, v77, v65
    v_mul_f32 v78, v78, v66
    v_mul_f32 v79, v79, v67
    v_cvt_pk_bf16_f32 v84, v79, v78
    v_cvt_pk_bf16_f32 v85, v77, v76
    v_cvt_pk_bf16_f32 v86, v75, v74
    v_cvt_pk_bf16_f32 v87, v73, v72
    ds_write_b128 v44, v[84:87] offset:128
    s_waitcnt lgkmcnt(0)
    s_barrier
    ds_read_b128 v[60:63], v98 offset:20480
    ds_read_b128 v[68:71], v98 offset:28672
    ds_read_b128 v[64:67], v99 offset:20480
    ds_read_b128 v[72:75], v99 offset:28672
    s_waitcnt lgkmcnt(0)
    buffer_store_dwordx4 v[60:63], v96, s[40:43], s46 offen sc1
    buffer_store_dwordx4 v[68:71], v96, s[36:39], s47 offen sc1
    buffer_store_dwordx4 v[64:67], v96, s[40:43], s48 offen sc1
    buffer_store_dwordx4 v[72:75], v96, s[36:39], s49 offen sc1
    s_barrier
    s_branch PA_END
PA_AUX:
    s_load_dwordx4 s[12:15], s[0:1], 72
    s_load_dwordx4 s[48:51], s[0:1], 56
    s_load_dwordx2 s[52:53], s[0:1], 32
    s_sub_u32 s16, s3, 4
    s_mul_hi_u32 s18, s2, 0x5555556
    s_mul_i32 s17, s18, 48
    s_sub_u32 s19, s2, s17
    v_and_b32 v1, 7, v0
    v_lshrrev_b32 v2, 3, v0
    s_lshl_b32 s17, s18, 2
    s_add_u32 s17, s17, s16
    s_lshl_b32 s17, s17, 3
    v_add_u32 v2, s17, v2
    v_mul_u32_u24 v3, 24576, v2
    v_lshl_add_u32 v3, v1, 4, v3
    s_lshl_b32 s17, s19, 7
    v_add_u32 v3, s17, v3
    v_lshlrev_b32 v4, 3, v2
    v_lshrrev_b32 v5, 5, v0
    s_lshl_b32 s17, s2, 3
    s_lshl_b32 s20, s16, 1
    s_add_u32 s17, s17, s20
    v_add_u32 v5, s17, v5
    v_and_b32 v6, 31, v0
    v_lshlrev_b32 v7, 10, v5
    v_lshl_add_u32 v7, v6, 4, v7
    s_mov_b32 s21, 6144
    s_mov_b32 s22, 12288
    s_mov_b32 s23, 18432
    v_lshlrev_b32 v100, 4, v0
    s_waitcnt lgkmcnt(0)
    s_mov_b32 s60, s70
    s_mov_b32 s61, s71
    s_mov_b32 s62, 0x100
    s_mov_b32 s63, 0x20000
    s_add_u32 s64, s4, 0x438000
    s_addc_u32 s65, s5, 0
    s_mov_b32 s66, 0x4000
    s_mov_b32 s67, 0x20000
    s_mov_b32 s24, s8
    s_mov_b32 s25, s9
    s_mov_b32 s26, 0x200000
    s_mov_b32 s27, 0x20000
    s_mov_b32 s28, s12
    s_mov_b32 s29, s13
    s_mov_b32 s30, 0x400
    s_mov_b32 s31, 0x20000
    s_mov_b32 s32, s14
    s_mov_b32 s33, s15
    s_mov_b32 s34, 0x300000
    s_mov_b32 s35, 0x20000
    s_cmp_lg_u32 s3, 7
    s_cbranch_scc1 PAY1
    s_cmp_lt_u32 s2, 248
    s_cbranch_scc1 PAY1
    s_and_b32 s55, s2, 7
    v_mov_b32 v111, 0
    v_lshlrev_b32 v110, 7, v0
    s_lshl_b32 s54, s55, 8
    s_mov_b64 exec, 3
    buffer_store_dword v111, v110, s[64:67], s54 offen sc1
    buffer_store_dword v111, v110, s[64:67], s54 offen offset:2048 sc1
    s_mov_b64 exec, -1
    v_lshlrev_b32 v110, 10, v0
    s_lshl_b32 s54, s55, 7
    s_add_u32 s54, s54, 0x1000
    s_mov_b64 exec, 15
    buffer_store_dword v111, v110, s[64:67], s54 offen sc1
    s_waitcnt vmcnt(0)
    v_mov_b32 v111, 1
    s_lshl_b32 s54, s55, 2
    s_mov_b64 exec, 1
    buffer_store_dword v111, off, s[60:63], s54 sc1
    s_mov_b64 exec, -1
PAY1:
    s_barrier
    buffer_load_dwordx4 v[8:11], v7, s[24:27], 0 offen
    buffer_load_dwordx4 v[12:15], v7, s[24:27], 0 offen offset:512
    s_cmp_ge_u32 s18, 4
    s_cbranch_scc1 PA_NOMODLD
    buffer_load_dwordx2 v[16:17], v4, s[28:31], 0 offen
    buffer_load_dwordx4 v[20:23], v3, s[32:35], 0 offen
    buffer_load_dwordx4 v[24:27], v3, s[32:35], s21 offen
    buffer_load_dwordx4 v[28:31], v3, s[32:35], s22 offen
    buffer_load_dwordx4 v[32:35], v3, s[32:35], s23 offen
PA_NOMODLD:
    s_cmp_ge_u32 s2, 224
    s_cbranch_scc1 PA_LDONE
    s_and_b32 s7, s2, 7
    s_lshr_b32 s6, s2, 3
    v_lshrrev_b32 v101, 3, v0
    v_and_b32 v102, 7, v0
    v_bfe_u32 v103, v0, 4, 1
    v_lshlrev_b32 v103, 2, v103
    v_xor_b32 v102, v102, v103
    v_mul_u32_u24 v101, 3584, v101
    v_lshl_add_u32 v101, v102, 4, v101
    s_lshl_b32 s17, s6, 7
    v_add_u32 v101, s17, v101
    s_lshl_b32 s54, s7, 2
    s_add_u32 s54, s54, s16
    s_mul_i32 s54, s54, 57344
    s_lshl_b32 s55, s16, 11
    s_add_u32 s55, s55, 4096
    s_mov_b32 s56, s48
    s_mov_b32 s57, s49
    s_mov_b32 s58, 0x1c0000
    s_mov_b32 s59, 0x20000
    s_mov_b32 m0, s55
    s_add_u32 s55, s55, 1024
    buffer_load_dwordx4 v101, s[56:59], s54 offen  lds
    s_add_u32 s54, s54, 28672
    s_mov_b32 m0, s55
    s_add_u32 s55, s55, 1024
    buffer_load_dwordx4 v101, s[56:59], s54 offen  lds
    s_add_u32 s54, s54, 28672
    s_branch PA_LDONE
PA_L56:
    s_lshl_b32 s6, s2, 1
    s_add_u32 s6, s6, s3
    s_sub_u32 s6, s6, 5
    s_and_b32 s7, s6, 3
    s_lshr_b32 s6, s6, 2
    v_lshrrev_b32 v101, 4, v0
    v_and_b32 v102, 15, v0
    v_lshlrev_b32 v103, 2, v101
    v_xor_b32 v102, v102, v103
    v_lshlrev_b32 v102, 4, v102
    v_lshl_add_u32 v101, v101, 10, v102
    s_lshl_b32 s17, s7, 8
    v_add_u32 v101, s17, v101
    s_lshl_b32 s54, s6, 14
    s_sub_u32 s55, s3, 5
    s_lshl_b32 s55, s55, 12
    s_add_u32 s55, s55, 12288
    s_mov_b32 s56, s50
    s_mov_b32 s57, s51
    s_mov_b32 s58, 0x1c0000
    s_mov_b32 s59, 0x20000
    s_mov_b32 m0, s55
    s_add_u32 s55, s55, 1024
    buffer_load_dwordx4 v101, s[56:59], s54 offen  lds
    s_add_u32 s54, s54, 4096
    s_mov_b32 m0, s55
    s_add_u32 s55, s55, 1024
    buffer_load_dwordx4 v101, s[56:59], s54 offen  lds
    s_add_u32 s54, s54, 4096
    s_mov_b32 m0, s55
    s_add_u32 s55, s55, 1024
    buffer_load_dwordx4 v101, s[56:59], s54 offen  lds
    s_add_u32 s54, s54, 4096
    s_mov_b32 m0, s55
    s_add_u32 s55, s55, 1024
    buffer_load_dwordx4 v101, s[56:59], s54 offen  lds
    s_add_u32 s54, s54, 4096
    s_branch PA_LDONE
PA_L7:
    s_branch PA_LDONE
    s_and_b32 s6, s2, 7
    s_lshl_b32 s6, s6, 6
    s_lshr_b32 s7, s2, 3
    s_lshl_b32 s7, s7, 1
    s_add_u32 s6, s6, s7
    s_lshl_b32 s54, s6, 12
    s_mov_b32 s56, s52
    s_mov_b32 s57, s53
    s_mov_b32 s58, 0x200000
    s_mov_b32 s59, 0x20000
    buffer_load_dwordx4 v[104:107], v100, s[56:59], s54 offen offset:0
    buffer_load_dwordx4 v[108:111], v100, s[56:59], s54 offen offset:1024
    buffer_load_dwordx4 v[112:115], v100, s[56:59], s54 offen offset:2048
    buffer_load_dwordx4 v[116:119], v100, s[56:59], s54 offen offset:3072
    s_add_u32 s54, s54, 4096
    buffer_load_dwordx4 v[104:107], v100, s[56:59], s54 offen offset:0
    buffer_load_dwordx4 v[108:111], v100, s[56:59], s54 offen offset:1024
    buffer_load_dwordx4 v[112:115], v100, s[56:59], s54 offen offset:2048
    buffer_load_dwordx4 v[116:119], v100, s[56:59], s54 offen offset:3072
PA_LDONE:
    s_barrier
    s_add_u32 s36, s4, 0x400000
    s_addc_u32 s37, s5, 0
    s_mov_b32 s38, 0x4000
    s_mov_b32 s39, 0x20000
    s_add_u32 s40, s4, 0x440000
    s_addc_u32 s41, s5, 0
    s_mov_b32 s42, 0xc000
    s_mov_b32 s43, 0x20000
    s_mov_b32 s44, 0x3f803f80
    v_mov_b32 v40, 0
    v_mov_b32 v41, 0
    v_mov_b32 v42, 0
    v_mov_b32 v43, 0
    s_waitcnt vmcnt(0)
    s_cmp_ge_u32 s18, 4
    s_cbranch_scc1 PA_NOMOD0
    v_lshlrev_b32 v50, 16, v16
    v_and_b32 v51, 0xffff0000, v16
    v_lshlrev_b32 v52, 16, v17
    v_and_b32 v53, 0xffff0000, v17
    s_mov_b32 s45, 0xbfb8aa3b
    v_mul_f32 v60, s45, v50
    v_mul_f32 v61, s45, v51
    v_mul_f32 v62, s45, v52
    v_mul_f32 v63, s45, v53
    v_exp_f32 v60, v60
    v_exp_f32 v61, v61
    v_exp_f32 v62, v62
    v_exp_f32 v63, v63
    s_nop 0
    v_add_f32 v60, 1.0, v60
    v_add_f32 v61, 1.0, v61
    v_add_f32 v62, 1.0, v62
    v_add_f32 v63, 1.0, v63
    v_rcp_f32 v60, v60
    v_rcp_f32 v61, v61
    v_rcp_f32 v62, v62
    v_rcp_f32 v63, v63
    s_nop 0
    v_mul_f32 v60, v50, v60
    v_mul_f32 v61, v51, v61
    v_mul_f32 v62, v52, v62
    v_mul_f32 v63, v53, v63
    v_cvt_pk_bf16_f32 v70, v60, v60
    v_cvt_pk_bf16_f32 v71, v61, v61
    v_cvt_pk_bf16_f32 v72, v62, v62
    v_cvt_pk_bf16_f32 v73, v63, v63
    v_and_b32 v60, 0xffff0000, v70
    v_and_b32 v61, 0xffff0000, v71
    v_and_b32 v62, 0xffff0000, v72
    v_and_b32 v63, 0xffff0000, v73
    v_and_b32 v70, 0xffff, v70
    v_and_b32 v71, 0xffff, v71
    v_and_b32 v72, 0xffff, v72
    v_and_b32 v73, 0xffff, v73
    v_mov_b32 v80, 0
    v_mov_b32 v81, 0
    v_mov_b32 v82, 0
    v_mov_b32 v83, 0
    v_mov_b32 v84, 0
    v_mov_b32 v85, 0
    v_mov_b32 v86, 0
    v_mov_b32 v87, 0
    v_dot2_f32_bf16 v80, v20, v70, v80
    v_dot2_f32_bf16 v81, v20, v60, v81
    v_dot2_f32_bf16 v82, v21, v70, v82
    v_dot2_f32_bf16 v83, v21, v60, v83
    v_dot2_f32_bf16 v84, v22, v70, v84
    v_dot2_f32_bf16 v85, v22, v60, v85
    v_dot2_f32_bf16 v86, v23, v70, v86
    v_dot2_f32_bf16 v87, v23, v60, v87
    v_dot2_f32_bf16 v80, v24, v71, v80
    v_dot2_f32_bf16 v81, v24, v61, v81
    v_dot2_f32_bf16 v82, v25, v71, v82
    v_dot2_f32_bf16 v83, v25, v61, v83
    v_dot2_f32_bf16 v84, v26, v71, v84
    v_dot2_f32_bf16 v85, v26, v61, v85
    v_dot2_f32_bf16 v86, v27, v71, v86
    v_dot2_f32_bf16 v87, v27, v61, v87
    v_dot2_f32_bf16 v80, v28, v72, v80
    v_dot2_f32_bf16 v81, v28, v62, v81
    v_dot2_f32_bf16 v82, v29, v72, v82
    v_dot2_f32_bf16 v83, v29, v62, v83
    v_dot2_f32_bf16 v84, v30, v72, v84
    v_dot2_f32_bf16 v85, v30, v62, v85
    v_dot2_f32_bf16 v86, v31, v72, v86
    v_dot2_f32_bf16 v87, v31, v62, v87
    v_dot2_f32_bf16 v80, v32, v73, v80
    v_dot2_f32_bf16 v81, v32, v63, v81
    v_dot2_f32_bf16 v82, v33, v73, v82
    v_dot2_f32_bf16 v83, v33, v63, v83
    v_dot2_f32_bf16 v84, v34, v73, v84
    v_dot2_f32_bf16 v85, v34, v63, v85
    v_dot2_f32_bf16 v86, v35, v73, v86
    v_dot2_f32_bf16 v87, v35, v63, v87
    s_nop 2
    v_add_f32_dpp v80, v80, v80 row_ror:8 row_mask:0xf bank_mask:0xf
    v_add_f32_dpp v81, v81, v81 row_ror:8 row_mask:0xf bank_mask:0xf
    v_add_f32_dpp v82, v82, v82 row_ror:8 row_mask:0xf bank_mask:0xf
    v_add_f32_dpp v83, v83, v83 row_ror:8 row_mask:0xf bank_mask:0xf
    v_add_f32_dpp v84, v84, v84 row_ror:8 row_mask:0xf bank_mask:0xf
    v_add_f32_dpp v85, v85, v85 row_ror:8 row_mask:0xf bank_mask:0xf
    v_add_f32_dpp v86, v86, v86 row_ror:8 row_mask:0xf bank_mask:0xf
    v_add_f32_dpp v87, v87, v87 row_ror:8 row_mask:0xf bank_mask:0xf
    v_lshrrev_b32 v90, 4, v0
    s_lshl_b32 s17, s16, 2
    v_add_u32 v90, s17, v90
    v_lshlrev_b32 v90, 8, v90
    v_lshl_add_u32 v90, v1, 5, v90
    v_add_u32 v90, 0, v90
    v_and_b32 v91, 15, v0
    v_cmp_gt_u32 vcc, 8, v91
    s_and_saveexec_b64 s[46:47], vcc
    ds_write_b128 v90, v[80:83]
    ds_write_b128 v90, v[84:87] offset:16
    s_mov_b64 exec, s[46:47]
PA_NOMOD0:
    v_dot2_f32_bf16 v40, v8, s44, v40
    v_dot2_f32_bf16 v42, v8, v8, v42
    v_dot2_f32_bf16 v41, v9, s44, v41
    v_dot2_f32_bf16 v43, v9, v9, v43
    v_dot2_f32_bf16 v40, v10, s44, v40
    v_dot2_f32_bf16 v42, v10, v10, v42
    v_dot2_f32_bf16 v41, v11, s44, v41
    v_dot2_f32_bf16 v43, v11, v11, v43
    v_dot2_f32_bf16 v40, v12, s44, v40
    v_dot2_f32_bf16 v42, v12, v12, v42
    v_dot2_f32_bf16 v41, v13, s44, v41
    v_dot2_f32_bf16 v43, v13, v13, v43
    v_dot2_f32_bf16 v40, v14, s44, v40
    v_dot2_f32_bf16 v42, v14, v14, v42
    v_dot2_f32_bf16 v41, v15, s44, v41
    v_dot2_f32_bf16 v43, v15, v15, v43
    s_nop 2
    v_add_f32 v40, v40, v41
    v_add_f32 v42, v42, v43
    s_nop 1
    v_add_f32_dpp v40, v40, v40 quad_perm:[1,0,3,2] row_mask:0xf bank_mask:0xf
    v_add_f32_dpp v42, v42, v42 quad_perm:[1,0,3,2] row_mask:0xf bank_mask:0xf
    s_nop 1
    v_add_f32_dpp v40, v40, v40 quad_perm:[2,3,0,1] row_mask:0xf bank_mask:0xf
    v_add_f32_dpp v42, v42, v42 quad_perm:[2,3,0,1] row_mask:0xf bank_mask:0xf
    s_nop 1
    v_add_f32_dpp v40, v40, v40 row_half_mirror row_mask:0xf bank_mask:0xf
    v_add_f32_dpp v42, v42, v42 row_half_mirror row_mask:0xf bank_mask:0xf
    s_nop 1
    v_add_f32_dpp v40, v40, v40 row_mirror row_mask:0xf bank_mask:0xf
    v_add_f32_dpp v42, v42, v42 row_mirror row_mask:0xf bank_mask:0xf
    s_nop 1
    v_add_f32_dpp v40, v40, v40 row_bcast:15 row_mask:0xa bank_mask:0xf
    v_add_f32_dpp v42, v42, v42 row_bcast:15 row_mask:0xa bank_mask:0xf
    v_mul_f32 v45, 0x3b000000, v40
    v_mul_f32 v46, 0x3b000000, v42
    v_fma_f32 v46, -v45, v45, v46
    v_max_f32 v46, 0, v46
    v_cvt_pk_bf16_f32 v46, v46, v46
    v_and_b32 v46, 0xffff0000, v46
    v_add_f32 v46, 0x3727c5ac, v46
    v_cvt_pk_bf16_f32 v46, v46, v46
    v_and_b32 v46, 0xffff0000, v46
    v_sqrt_f32 v46, v46
    s_nop 0
    v_cvt_pk_bf16_f32 v46, v46, v46
    v_and_b32 v46, 0xffff0000, v46
    v_rcp_f32 v44, v46
    v_cvt_pk_bf16_f32 v45, v45, v45
    v_and_b32 v45, 0xffff0000, v45
    v_mul_f32 v45, v45, v44
    v_sub_f32 v45, 0, v45
    v_lshlrev_b32 v46, 2, v5
    v_cmp_eq_u32 vcc, 16, v6
    s_movk_i32 s45, 0x2000
    s_and_saveexec_b64 s[46:47], vcc
    buffer_store_dword v44, v46, s[36:39], 0 offen sc1
    buffer_store_dword v45, v46, s[36:39], s45 offen sc1
    s_add_u32 s56, s4, 0x420000
    s_addc_u32 s57, s5, 0
    s_mov_b32 s58, 0x4000
    s_mov_b32 s59, 0x20000
    v_lshlrev_b32 v46, 3, v5
    v_mov_b32 v48, 0
    v_mov_b32 v49, 0
    buffer_store_dwordx2 v[48:49], v46, s[56:59], 0 offen sc1
    s_mov_b64 exec, s[46:47]
    s_cmp_ge_u32 s2, 224
    s_cbranch_scc1 PA_WDONE
    s_add_u32 s56, s4, 0x900000
    s_addc_u32 s57, s5, 0
    s_mov_b32 s58, 0x1c0000
    s_mov_b32 s59, 0x20000
    v_bfe_u32 v101, v0, 2, 2
    v_lshrrev_b32 v102, 5, v0
    v_lshl_add_u32 v102, v102, 3, v101
    v_lshlrev_b32 v102, 7, v102
    v_bfe_u32 v103, v0, 4, 1
    v_lshl_add_u32 v102, v103, 5, v102
    v_and_b32 v103, 3, v0
    v_lshl_add_u32 v102, v103, 3, v102
    v_lshrrev_b32 v101, 1, v101
    v_lshl_add_u32 v101, v101, 6, v102
    s_lshl_b32 s55, s16, 11
    s_add_u32 s55, s55, 4096
    v_add_u32 v101, s55, v101
    v_xor_b32 v102, 64, v101
    ds_read_b64_tr_b16 v[104:105], v101
    ds_read_b64_tr_b16 v[106:107], v101 offset:512
    ds_read_b64_tr_b16 v[108:109], v102
    ds_read_b64_tr_b16 v[110:111], v102 offset:512
    s_lshl_b32 s54, s6, 16
    s_lshl_b32 s55, s7, 2
    s_add_u32 s55, s55, s16
    s_lshl_b32 s55, s55, 10
    s_add_u32 s54, s54, s55
    s_add_u32 s55, s54, 32768
    s_waitcnt lgkmcnt(0)
    buffer_store_dwordx4 v[104:107], v100, s[56:59], s54 offen sc1
    buffer_store_dwordx4 v[108:111], v100, s[56:59], s55 offen sc1
    s_branch PA_WDONE
PA_S56:
    s_add_u32 s56, s4, 0xb00000
    s_addc_u32 s57, s5, 0
    s_mov_b32 s58, 0x1c0000
    s_mov_b32 s59, 0x20000
    v_bfe_u32 v101, v0, 2, 2
    v_lshrrev_b32 v102, 5, v0
    v_lshl_add_u32 v102, v102, 2, v101
    v_lshlrev_b32 v102, 8, v102
    v_bfe_u32 v103, v0, 4, 1
    v_lshl_add_u32 v102, v103, 5, v102
    v_and_b32 v103, 3, v0
    v_lshl_add_u32 v102, v103, 3, v102
    s_sub_u32 s55, s3, 5
    s_lshl_b32 s55, s55, 12
    s_add_u32 s55, s55, 12288
    v_add_u32 v102, s55, v102
    v_xor_b32 v103, 0, v101
    v_lshl_add_u32 v103, v103, 6, v102
    ds_read_b64_tr_b16 v[104:105], v103
    ds_read_b64_tr_b16 v[106:107], v103 offset:2048
    v_xor_b32 v103, 1, v101
    v_lshl_add_u32 v103, v103, 6, v102
    ds_read_b64_tr_b16 v[108:109], v103
    ds_read_b64_tr_b16 v[110:111], v103 offset:2048
    v_xor_b32 v103, 2, v101
    v_lshl_add_u32 v103, v103, 6, v102
    ds_read_b64_tr_b16 v[112:113], v103
    ds_read_b64_tr_b16 v[114:115], v103 offset:2048
    v_xor_b32 v103, 3, v101
    v_lshl_add_u32 v103, v103, 6, v102
    ds_read_b64_tr_b16 v[116:117], v103
    ds_read_b64_tr_b16 v[118:119], v103 offset:2048
    s_mul_i32 s54, s7, 458752
    s_lshl_b32 s55, s6, 10
    s_add_u32 s54, s54, s55
    s_waitcnt lgkmcnt(0)
    buffer_store_dwordx4 v[104:107], v100, s[56:59], s54 offen sc1
    s_add_u32 s54, s54, 114688
    buffer_store_dwordx4 v[108:111], v100, s[56:59], s54 offen sc1
    s_add_u32 s54, s54, 114688
    buffer_store_dwordx4 v[112:115], v100, s[56:59], s54 offen sc1
    s_add_u32 s54, s54, 114688
    buffer_store_dwordx4 v[116:119], v100, s[56:59], s54 offen sc1
    s_add_u32 s54, s54, 114688
PA_WDONE:
    v_lshlrev_b32 v112, 2, v0
    s_mov_b64 exec, 0xff
    buffer_load_dword v111, v112, s[60:63], 0 offen sc1
    s_mov_b64 exec, -1
PA_NOMOD:
    s_waitcnt lgkmcnt(0)
    s_barrier
    s_cmp_ge_u32 s18, 4
    s_cbranch_scc1 PA_END
    s_cmp_lg_u32 s3, 5
    s_cbranch_scc1 PA_END
    v_lshlrev_b32 v5, 2, v0
    ds_read_b32 v8, v5 offset:0
    ds_read_b32 v9, v5 offset:256
    ds_read_b32 v10, v5 offset:512
    ds_read_b32 v11, v5 offset:768
    ds_read_b32 v12, v5 offset:1024
    ds_read_b32 v13, v5 offset:1280
    ds_read_b32 v14, v5 offset:1536
    ds_read_b32 v15, v5 offset:1792
    ds_read_b32 v16, v5 offset:2048
    ds_read_b32 v17, v5 offset:2304
    ds_read_b32 v18, v5 offset:2560
    ds_read_b32 v19, v5 offset:2816
    ds_read_b32 v20, v5 offset:3072
    ds_read_b32 v21, v5 offset:3328
    ds_read_b32 v22, v5 offset:3584
    s_waitcnt lgkmcnt(0)
    ds_read_b32 v23, v5 offset:3840
    s_waitcnt lgkmcnt(0)
    v_add_f32 v8, v8, v16
    v_add_f32 v9, v9, v17
    v_add_f32 v10, v10, v18
    v_add_f32 v11, v11, v19
    v_add_f32 v12, v12, v20
    v_add_f32 v13, v13, v21
    v_add_f32 v14, v14, v22
    v_add_f32 v15, v15, v23
    v_add_f32 v8, v8, v12
    v_add_f32 v9, v9, v13
    v_add_f32 v10, v10, v14
    v_add_f32 v11, v11, v15
    v_add_f32 v8, v8, v10
    v_add_f32 v9, v9, v11
    v_add_f32 v8, v8, v9
    s_mul_i32 s17, s18, 12288
    s_lshl_b32 s20, s19, 8
    s_add_u32 s17, s17, s20
    buffer_store_dword v8, v5, s[40:43], s17 offen sc1
PA_END:
    s_waitcnt vmcnt(0) lgkmcnt(0)
    s_barrier
    s_cmp_lg_u32 s3, 7
    s_cbranch_scc1 ARS2
    v_mov_b32 v1, 1
    s_mov_b64 exec, 1
    s_mov_b32 s69, 200000
    s_mov_b64 exec, 0xff
    v_lshlrev_b32 v112, 2, v0
INI2:
    v_cmp_eq_u32 vcc, 0, v111
    s_cmp_eq_u64 vcc, 0
    s_cbranch_scc1 INJ2
    buffer_load_dword v111, v112, s[60:63], 0 offen sc1
    s_waitcnt vmcnt(0)
    s_sub_u32 s69, s69, 1
    s_cbranch_scc0 INI2
INJ2:
    s_mov_b64 exec, 1
    s_and_b32 s68, s2, 7
    s_lshl_b32 s68, s68, 8
    buffer_atomic_add v1, off, s[64:67], s68 sc0 sc1
    s_mov_b64 exec, -1
ARS2:
    s_cmp_lg_u32 s3, 7
    s_cbranch_scc1 ARR2
    s_waitcnt vmcnt(0)
    v_readfirstlane_b32 s69, v1
    s_cmp_lg_u32 s69, 31
    s_cbranch_scc1 ARR2
    v_mov_b32 v1, 1
    s_mov_b64 exec, 1
    buffer_store_dword v1, off, s[64:67], s68 offset:128 sc1
    s_mov_b64 exec, -1
ARR2:
    s_barrier
    s_cmp_ge_u32 s3, 4
    s_cbranch_scc1 PB_PREP
    s_load_dwordx4 s[8:11], s[0:1], 32
    s_lshr_b32 s6, s3, 1
    s_and_b32 s12, s3, 1
    s_and_b32 s13, s2, 7
    s_lshl_b32 s13, s13, 6
    s_lshr_b32 s14, s2, 3
    s_lshl_b32 s14, s14, 1
    s_add_u32 s13, s13, s14
    s_add_u32 s13, s13, s6
    s_lshl_b32 s14, s13, 12
    s_mul_i32 s15, s6, 21248
    v_lshlrev_b32 v2, 4, v0
    s_waitcnt lgkmcnt(0)
    s_mov_b32 s28, s8
    s_mov_b32 s29, s9
    s_mov_b32 s30, 0x200000
    s_mov_b32 s31, 0x20000
    buffer_load_dwordx2 v[18:19], off, s[28:31], s14
    s_lshl_b32 s48, s12, 2
    s_add_u32 s49, s14, s48
    s_add_u32 s49, s49, 2
    s_mul_i32 s50, s12, 8320
    s_add_u32 s50, s50, s15
    s_add_u32 s50, s50, 4640
    s_mov_b32 m0, s50
    s_nop 0
    buffer_load_dwordx4 v2, s[28:31], s49 offen offset:0  lds
    buffer_load_dwordx4 v2, s[28:31], s49 offen offset:1024  lds
    buffer_load_dwordx4 v2, s[28:31], s49 offen offset:2048  lds
    buffer_load_dwordx4 v2, s[28:31], s49 offen offset:3072  lds
    s_lshl_b32 s48, s12, 2
    s_add_u32 s49, s14, s48
    s_add_u32 s49, s49, 4
    s_mul_i32 s50, s12, 8320
    s_add_u32 s50, s50, s15
    s_add_u32 s50, s50, 8800
    s_mov_b32 m0, s50
    s_nop 0
    buffer_load_dwordx4 v2, s[28:31], s49 offen offset:0  lds
    buffer_load_dwordx4 v2, s[28:31], s49 offen offset:1024  lds
    buffer_load_dwordx4 v2, s[28:31], s49 offen offset:2048  lds
    buffer_load_dwordx4 v2, s[28:31], s49 offen offset:3072  lds
    s_add_u32 s36, s4, 0x200000
    s_addc_u32 s37, s5, 0
    s_mov_b32 s38, 0x200000
    s_mov_b32 s39, 0x20000
    s_add_u32 s40, s4, 0x400000
    s_addc_u32 s41, s5, 0
    s_mov_b32 s42, 0x4000
    s_mov_b32 s43, 0x20000
    s_add_u32 s44, s4, 0x500000
    s_addc_u32 s45, s5, 0
    s_mov_b32 s46, 0x200000
    s_mov_b32 s47, 0x20000
    s_mov_b32 s52, s10
    s_mov_b32 s53, s11
    s_mov_b32 s54, 0x400
    s_mov_b32 s55, 0x20000
    s_add_u32 s56, s4, 0x440000
    s_addc_u32 s57, s5, 0
    s_mov_b32 s58, 0xc000
    s_mov_b32 s59, 0x20000
    v_and_b32 v3, 15, v0
    v_lshrrev_b32 v4, 4, v0
    v_lshlrev_b32 v5, 4, v3
    v_lshl_add_u32 v5, v4, 2, v5
    s_lshl_b32 s48, s12, 10
    v_add_u32 v5, s48, v5
    v_lshlrev_b32 v6, 1, v5
    v_lshlrev_b32 v7, 2, v5
    s_lshl_b32 s20, s13, 1
    buffer_load_ushort v240, off, s[52:55], s20
    v_and_b32 v241, 3, v0
    v_cmp_eq_u32 vcc, 3, v241
    s_nop 1
    v_addc_co_u32 v241, vcc, 0, v241, vcc
    v_lshlrev_b32 v241, 11, v241
    v_bfe_u32 v242, v0, 2, 2
    v_mul_u32_u24 v242, 12288, v242
    v_add_u32 v241, v241, v242
    s_add_u32 s8, s4, 0x1500000
    s_addc_u32 s9, s5, 0
    s_mov_b32 s10, 0x200000
    s_mov_b32 s11, 0x20000
    v_mov_b32 v8, 0
    v_mov_b32 v9, 0
    v_mov_b32 v10, 0
    v_mov_b32 v11, 0
    v_lshlrev_b32 v12, 3, v0
    s_add_u32 s48, s15, 4096
    v_add_u32 v12, s48, v12
    ds_write_b64 v12, v[8:9]
    v_bfe_u32 v14, v0, 2, 2
    v_mul_u32_u24 v14, 4160, v14
    v_and_b32 v15, 3, v0
    v_lshl_add_u32 v14, v15, 3, v14
    v_lshl_add_u32 v14, v4, 4, v14
    s_lshl_b32 s48, s12, 8
    s_add_u32 s48, s48, s15
    s_add_u32 s49, s48, 4608
    v_add_u32 v14, s49, v14
    v_lshlrev_b32 v15, 4, v4
    v_lshlrev_b32 v16, 5, v3
    v_sub_u32 v15, v15, v16
    s_add_u32 s49, s48, 480
    v_add_u32 v15, s49, v15
    v_mov_b32 v20, 0
    v_mov_b32 v21, 0
    v_mov_b32 v22, 0
    v_mov_b32 v23, 0
    v_mov_b32 v24, 0
    v_mov_b32 v25, 0
    v_mov_b32 v26, 0
    v_mov_b32 v27, 0
    v_mov_b32 v28, 0
    v_mov_b32 v29, 0
    v_mov_b32 v30, 0
    v_mov_b32 v31, 0
    v_mov_b32 v32, 0
    v_mov_b32 v33, 0
    v_mov_b32 v34, 0
    v_mov_b32 v35, 0
    v_mov_b32 v36, 0
    v_mov_b32 v37, 0
    v_mov_b32 v38, 0
    v_mov_b32 v39, 0
    v_mov_b32 v40, 0
    v_mov_b32 v41, 0
    v_mov_b32 v42, 0
    v_mov_b32 v43, 0
    v_mov_b32 v44, 0
    v_mov_b32 v45, 0
    v_mov_b32 v46, 0
    v_mov_b32 v47, 0
    v_mov_b32 v48, 0
    v_mov_b32 v49, 0
    v_mov_b32 v50, 0
    v_mov_b32 v51, 0
    v_lshrrev_b32 v12, 1, v0
    v_mul_u32_u24 v12, 4160, v12
    v_and_b32 v13, 1, v0
    v_lshl_add_u32 v12, v13, 4, v12
    s_mul_i32 s50, s12, 8320
    s_add_u32 s50, s50, s15
    s_add_u32 s50, s50, 4608
    v_add_u32 v12, s50, v12
    s_waitcnt vmcnt(9)
    v_lshlrev_b32 v52, 16, v18
    v_alignbit_b32 v53, v19, v18, 16
    v_cmp_eq_u32 vcc, 1, v0
    s_cmp_eq_u32 s12, 0
    s_cbranch_scc0 PB_FX1
    v_cndmask_b32 v11, v18, v52, vcc
    s_branch PB_FX2
PB_FX1:
    v_cndmask_b32 v10, v18, v52, vcc
    v_cndmask_b32 v11, v19, v53, vcc
PB_FX2:
    v_cmp_eq_u32 vcc, 1, v13
    s_nop 1
    v_cndmask_b32 v10, 0, v10, vcc
    v_cndmask_b32 v11, 0, v11, vcc
    s_mov_b64 exec, 0xf
    ds_write_b128 v12, v[8:11]
    s_mov_b64 exec, -1
    s_mov_b32 s32, s4
    s_mov_b32 s33, s5
    s_mov_b32 s34, 0x200000
    s_mov_b32 s35, 0x20000
    s_lshl_b32 s48, s12, 11
    s_add_u32 s49, s14, s48
    s_add_u32 s50, s15, s48
    s_barrier
    s_mov_b32 m0, s50
    s_nop 0
    buffer_load_dwordx4 v2, s[32:35], s49 offen sc1 lds
    buffer_load_dwordx4 v2, s[32:35], s49 offen offset:1024 sc1 lds
    buffer_load_dwordx2 v[200:201], v6, s[36:39], s14 offen offset:0 sc1
    buffer_load_dwordx2 v[202:203], v6, s[36:39], s14 offen offset:512 sc1
    buffer_load_dwordx2 v[204:205], v6, s[36:39], s14 offen offset:1024 sc1
    buffer_load_dwordx2 v[206:207], v6, s[36:39], s14 offen offset:1536 sc1
    s_movk_i32 s51, 0x2000
    buffer_load_dwordx4 v[208:211], v7, s[40:43], 0 offen offset:0 sc1
    buffer_load_dwordx4 v[212:215], v7, s[40:43], s51 offen offset:0 sc1
    buffer_load_dwordx4 v[216:219], v7, s[40:43], 0 offen offset:1024 sc1
    buffer_load_dwordx4 v[220:223], v7, s[40:43], s51 offen offset:1024 sc1
    buffer_load_dwordx4 v[224:227], v7, s[40:43], 0 offen offset:2048 sc1
    buffer_load_dwordx4 v[228:231], v7, s[40:43], s51 offen offset:2048 sc1
    buffer_load_dwordx4 v[232:235], v7, s[40:43], 0 offen offset:3072 sc1
    buffer_load_dwordx4 v[236:239], v7, s[40:43], s51 offen offset:3072 sc1
    s_lshl_b32 s20, s13, 2
    buffer_load_dword v241, v241, s[56:59], s20 offen sc1
    s_waitcnt vmcnt(13) lgkmcnt(0)
    s_barrier
    s_lshl_b32 s16, s3, 12
    s_add_u32 s16, s16, 42496
    v_add_u32 v16, s16, v2
    s_xor_b32 s17, s3, 1
    s_lshl_b32 s17, s17, 12
    s_add_u32 s17, s17, 42496
    v_add_u32 v17, s17, v2
    v_bfe_u32 v9, v0, 4, 1
    v_lshlrev_b32 v9, 9, v9
    v_lshl_add_u32 v9, v3, 5, v9
    v_lshrrev_b32 v8, 5, v0
    v_lshl_add_u32 v9, v8, 4, v9
    s_lshl_b32 s16, s12, 11
    s_add_u32 s16, s16, s14
    s_add_u32 s17, s16, 1024
    ds_read_b128 v[96:99], v15 offset:3584
    ds_read_b64_tr_b16 v[64:65], v14 offset:0
    ds_read_b64_tr_b16 v[66:67], v14 offset:8
    ds_read_b128 v[100:103], v15 offset:3072
    ds_read_b64_tr_b16 v[68:69], v14 offset:512
    ds_read_b64_tr_b16 v[70:71], v14 offset:520
    ds_read_b128 v[104:107], v15 offset:2560
    ds_read_b64_tr_b16 v[72:73], v14 offset:1024
    ds_read_b64_tr_b16 v[74:75], v14 offset:1032
    ds_read_b128 v[108:111], v15 offset:2048
    ds_read_b64_tr_b16 v[76:77], v14 offset:1536
    ds_read_b64_tr_b16 v[78:79], v14 offset:1544
    ds_read_b128 v[112:115], v15 offset:1536
    ds_read_b64_tr_b16 v[80:81], v14 offset:2048
    ds_read_b64_tr_b16 v[82:83], v14 offset:2056
    ds_read_b128 v[116:119], v15 offset:1024
    ds_read_b64_tr_b16 v[84:85], v14 offset:2560
    ds_read_b64_tr_b16 v[86:87], v14 offset:2568
    ds_read_b128 v[120:123], v15 offset:512
    ds_read_b64_tr_b16 v[88:89], v14 offset:3072
    ds_read_b64_tr_b16 v[90:91], v14 offset:3080
    ds_read_b128 v[124:127], v15 offset:0
    ds_read_b64_tr_b16 v[92:93], v14 offset:3584
    ds_read_b64_tr_b16 v[94:95], v14 offset:3592
    s_waitcnt lgkmcnt(15)
    v_mfma_f32_16x16x32_bf16 v[20:23], v[64:67], v[96:99], v[20:23]
    s_waitcnt lgkmcnt(15)
    v_mfma_f32_16x16x32_bf16 v[24:27], v[64:67], v[100:103], v[24:27]
    v_mfma_f32_16x16x32_bf16 v[24:27], v[68:71], v[96:99], v[24:27]
    v_mfma_f32_16x16x32_bf16 v[28:31], v[68:71], v[100:103], v[28:31]
    s_waitcnt lgkmcnt(15)
    v_mfma_f32_16x16x32_bf16 v[28:31], v[64:67], v[104:107], v[28:31]
    v_mfma_f32_16x16x32_bf16 v[32:35], v[68:71], v[104:107], v[32:35]
    v_mfma_f32_16x16x32_bf16 v[28:31], v[72:75], v[96:99], v[28:31]
    v_mfma_f32_16x16x32_bf16 v[32:35], v[72:75], v[100:103], v[32:35]
    v_mfma_f32_16x16x32_bf16 v[36:39], v[72:75], v[104:107], v[36:39]
    ds_read_b128 v[160:163], v15 offset:3648
    s_waitcnt lgkmcnt(13)
    v_mfma_f32_16x16x32_bf16 v[32:35], v[64:67], v[108:111], v[32:35]
    ds_read_b64_tr_b16 v[128:129], v14 offset:64
    v_mfma_f32_16x16x32_bf16 v[36:39], v[68:71], v[108:111], v[36:39]
    ds_read_b64_tr_b16 v[130:131], v14 offset:72
    v_mfma_f32_16x16x32_bf16 v[40:43], v[72:75], v[108:111], v[40:43]
    ds_read_b128 v[164:167], v15 offset:3136
    v_mfma_f32_16x16x32_bf16 v[32:35], v[76:79], v[96:99], v[32:35]
    ds_read_b64_tr_b16 v[132:133], v14 offset:576
    v_mfma_f32_16x16x32_bf16 v[36:39], v[76:79], v[100:103], v[36:39]
    ds_read_b64_tr_b16 v[134:135], v14 offset:584
    v_mfma_f32_16x16x32_bf16 v[40:43], v[76:79], v[104:107], v[40:43]
    ds_read_b128 v[168:171], v15 offset:2624
    v_mfma_f32_16x16x32_bf16 v[44:47], v[76:79], v[108:111], v[44:47]
    ds_read_b64_tr_b16 v[136:137], v14 offset:1088
    s_waitcnt lgkmcnt(15)
    v_mfma_f32_16x16x32_bf16 v[36:39], v[64:67], v[112:115], v[36:39]
    ds_read_b64_tr_b16 v[138:139], v14 offset:1096
    v_mfma_f32_16x16x32_bf16 v[40:43], v[68:71], v[112:115], v[40:43]
    ds_read_b128 v[172:175], v15 offset:2112
    v_mfma_f32_16x16x32_bf16 v[44:47], v[72:75], v[112:115], v[44:47]
    ds_read_b64_tr_b16 v[140:141], v14 offset:1600
    v_mfma_f32_16x16x32_bf16 v[48:51], v[76:79], v[112:115], v[48:51]
    ds_read_b64_tr_b16 v[142:143], v14 offset:1608
    v_mfma_f32_16x16x32_bf16 v[36:39], v[80:83], v[96:99], v[36:39]
    ds_read_b128 v[176:179], v15 offset:1600
    v_mfma_f32_16x16x32_bf16 v[40:43], v[80:83], v[100:103], v[40:43]
    ds_read_b64_tr_b16 v[144:145], v14 offset:2112
    v_mfma_f32_16x16x32_bf16 v[44:47], v[80:83], v[104:107], v[44:47]
    ds_read_b64_tr_b16 v[146:147], v14 offset:2120
    v_mfma_f32_16x16x32_bf16 v[48:51], v[80:83], v[108:111], v[48:51]
    ds_read_b128 v[180:183], v15 offset:1088
    s_waitcnt lgkmcnt(15)
    v_mfma_f32_16x16x32_bf16 v[40:43], v[64:67], v[116:119], v[40:43]
    ds_read_b64_tr_b16 v[148:149], v14 offset:2624
    v_mfma_f32_16x16x32_bf16 v[44:47], v[68:71], v[116:119], v[44:47]
    ds_read_b64_tr_b16 v[150:151], v14 offset:2632
    v_mfma_f32_16x16x32_bf16 v[48:51], v[72:75], v[116:119], v[48:51]
    ds_read_b128 v[184:187], v15 offset:576
    v_mfma_f32_16x16x32_bf16 v[40:43], v[84:87], v[96:99], v[40:43]
    ds_read_b64_tr_b16 v[152:153], v14 offset:3136
    v_mfma_f32_16x16x32_bf16 v[44:47], v[84:87], v[100:103], v[44:47]
    ds_read_b64_tr_b16 v[154:155], v14 offset:3144
    v_mfma_f32_16x16x32_bf16 v[48:51], v[84:87], v[104:107], v[48:51]
    ds_read_b128 v[188:191], v15 offset:64
    s_waitcnt lgkmcnt(15)
    v_mfma_f32_16x16x32_bf16 v[44:47], v[64:67], v[120:123], v[44:47]
    ds_read_b64_tr_b16 v[156:157], v14 offset:3648
    v_mfma_f32_16x16x32_bf16 v[48:51], v[68:71], v[120:123], v[48:51]
    ds_read_b64_tr_b16 v[158:159], v14 offset:3656
    v_mfma_f32_16x16x32_bf16 v[44:47], v[88:91], v[96:99], v[44:47]
    v_mfma_f32_16x16x32_bf16 v[48:51], v[88:91], v[100:103], v[48:51]
    s_waitcnt lgkmcnt(15)
    v_mfma_f32_16x16x32_bf16 v[48:51], v[64:67], v[124:127], v[48:51]
    v_mfma_f32_16x16x32_bf16 v[48:51], v[92:95], v[96:99], v[48:51]
    s_waitcnt lgkmcnt(0)
    v_mfma_f32_16x16x32_bf16 v[20:23], v[128:131], v[160:163], v[20:23]
    ds_read_b128 v[96:99], v15 offset:3712
    v_mfma_f32_16x16x32_bf16 v[24:27], v[128:131], v[164:167], v[24:27]
    ds_read_b64_tr_b16 v[64:65], v14 offset:128
    v_mfma_f32_16x16x32_bf16 v[24:27], v[132:135], v[160:163], v[24:27]
    ds_read_b64_tr_b16 v[66:67], v14 offset:136
    v_mfma_f32_16x16x32_bf16 v[28:31], v[132:135], v[164:167], v[28:31]
    ds_read_b128 v[100:103], v15 offset:3200
    v_mfma_f32_16x16x32_bf16 v[28:31], v[128:131], v[168:171], v[28:31]
    ds_read_b64_tr_b16 v[68:69], v14 offset:640
    v_mfma_f32_16x16x32_bf16 v[32:35], v[132:135], v[168:171], v[32:35]
    ds_read_b64_tr_b16 v[70:71], v14 offset:648
    v_mfma_f32_16x16x32_bf16 v[28:31], v[136:139], v[160:163], v[28:31]
    ds_read_b128 v[104:107], v15 offset:2688
    v_mfma_f32_16x16x32_bf16 v[32:35], v[136:139], v[164:167], v[32:35]
    ds_read_b64_tr_b16 v[72:73], v14 offset:1152
    v_mfma_f32_16x16x32_bf16 v[36:39], v[136:139], v[168:171], v[36:39]
    ds_read_b64_tr_b16 v[74:75], v14 offset:1160
    v_mfma_f32_16x16x32_bf16 v[32:35], v[128:131], v[172:175], v[32:35]
    ds_read_b128 v[108:111], v15 offset:2176
    v_mfma_f32_16x16x32_bf16 v[36:39], v[132:135], v[172:175], v[36:39]
    ds_read_b64_tr_b16 v[76:77], v14 offset:1664
    v_mfma_f32_16x16x32_bf16 v[40:43], v[136:139], v[172:175], v[40:43]
    ds_read_b64_tr_b16 v[78:79], v14 offset:1672
    v_mfma_f32_16x16x32_bf16 v[32:35], v[140:143], v[160:163], v[32:35]
    ds_read_b128 v[112:115], v15 offset:1664
    v_mfma_f32_16x16x32_bf16 v[36:39], v[140:143], v[164:167], v[36:39]
    ds_read_b64_tr_b16 v[80:81], v14 offset:2176
    v_mfma_f32_16x16x32_bf16 v[40:43], v[140:143], v[168:171], v[40:43]
    ds_read_b64_tr_b16 v[82:83], v14 offset:2184
    v_mfma_f32_16x16x32_bf16 v[44:47], v[140:143], v[172:175], v[44:47]
    ds_read_b128 v[116:119], v15 offset:1152
    v_mfma_f32_16x16x32_bf16 v[36:39], v[128:131], v[176:179], v[36:39]
    ds_read_b64_tr_b16 v[84:85], v14 offset:2688
    v_mfma_f32_16x16x32_bf16 v[40:43], v[132:135], v[176:179], v[40:43]
    ds_read_b64_tr_b16 v[86:87], v14 offset:2696
    v_mfma_f32_16x16x32_bf16 v[44:47], v[136:139], v[176:179], v[44:47]
    ds_read_b128 v[120:123], v15 offset:640
    v_mfma_f32_16x16x32_bf16 v[48:51], v[140:143], v[176:179], v[48:51]
    ds_read_b64_tr_b16 v[88:89], v14 offset:3200
    v_mfma_f32_16x16x32_bf16 v[36:39], v[144:147], v[160:163], v[36:39]
    ds_read_b64_tr_b16 v[90:91], v14 offset:3208
    v_mfma_f32_16x16x32_bf16 v[40:43], v[144:147], v[164:167], v[40:43]
    ds_read_b128 v[124:127], v15 offset:128
    v_mfma_f32_16x16x32_bf16 v[44:47], v[144:147], v[168:171], v[44:47]
    ds_read_b64_tr_b16 v[92:93], v14 offset:3712
    v_mfma_f32_16x16x32_bf16 v[48:51], v[144:147], v[172:175], v[48:51]
    ds_read_b64_tr_b16 v[94:95], v14 offset:3720
    v_mfma_f32_16x16x32_bf16 v[40:43], v[128:131], v[180:183], v[40:43]
    v_mfma_f32_16x16x32_bf16 v[44:47], v[132:135], v[180:183], v[44:47]
    v_mfma_f32_16x16x32_bf16 v[48:51], v[136:139], v[180:183], v[48:51]
    v_mfma_f32_16x16x32_bf16 v[40:43], v[148:151], v[160:163], v[40:43]
    v_mfma_f32_16x16x32_bf16 v[44:47], v[148:151], v[164:167], v[44:47]
    v_mfma_f32_16x16x32_bf16 v[48:51], v[148:151], v[168:171], v[48:51]
    v_mfma_f32_16x16x32_bf16 v[44:47], v[128:131], v[184:187], v[44:47]
    v_mfma_f32_16x16x32_bf16 v[48:51], v[132:135], v[184:187], v[48:51]
    v_mfma_f32_16x16x32_bf16 v[44:47], v[152:155], v[160:163], v[44:47]
    v_mfma_f32_16x16x32_bf16 v[48:51], v[152:155], v[164:167], v[48:51]
    v_mfma_f32_16x16x32_bf16 v[48:51], v[128:131], v[188:191], v[48:51]
    v_mfma_f32_16x16x32_bf16 v[48:51], v[156:159], v[160:163], v[48:51]
    s_waitcnt lgkmcnt(0)
    s_waitcnt vmcnt(0)
    v_lshlrev_b32 v240, 16, v240
    v_add_f32_dpp v241, v241, v241 row_ror:4 row_mask:0xf bank_mask:0xf
    s_nop 1
    v_add_f32_dpp v241, v241, v241 row_ror:8 row_mask:0xf bank_mask:0xf
    v_cvt_pk_bf16_f32 v241, v241, v241
    v_and_b32 v241, 0xffff0000, v241
    v_add_f32 v242, 1.0, v241
    v_cvt_pk_bf16_f32 v242, v242, v242
    v_and_b32 v242, 0xffff0000, v242
    s_nop 0
    v_readlane_b32 s52, v241, 0
    v_readlane_b32 s53, v242, 1
    v_readlane_b32 s54, v241, 2
    v_readlane_b32 s55, v242, 3
    s_nop 1
    v_mov_b32 v242, s53
    v_mov_b32 v243, s52
    v_mul_f32 v242, s54, v242
    v_mul_f32 v243, s54, v243
    v_mov_b32 v244, s55
    v_mfma_f32_16x16x32_bf16 v[20:23], v[64:67], v[96:99], v[20:23]
    ds_read_b128 v[160:163], v15 offset:3776
    v_mfma_f32_16x16x32_bf16 v[24:27], v[64:67], v[100:103], v[24:27]
    ds_read_b64_tr_b16 v[128:129], v14 offset:192
    v_mfma_f32_16x16x32_bf16 v[24:27], v[68:71], v[96:99], v[24:27]
    ds_read_b64_tr_b16 v[130:131], v14 offset:200
    v_mfma_f32_16x16x32_bf16 v[28:31], v[68:71], v[100:103], v[28:31]
    ds_read_b128 v[164:167], v15 offset:3264
    v_mfma_f32_16x16x32_bf16 v[28:31], v[64:67], v[104:107], v[28:31]
    ds_read_b64_tr_b16 v[132:133], v14 offset:704
    v_mfma_f32_16x16x32_bf16 v[32:35], v[68:71], v[104:107], v[32:35]
    ds_read_b64_tr_b16 v[134:135], v14 offset:712
    v_mfma_f32_16x16x32_bf16 v[28:31], v[72:75], v[96:99], v[28:31]
    ds_read_b128 v[168:171], v15 offset:2752
    v_mfma_f32_16x16x32_bf16 v[32:35], v[72:75], v[100:103], v[32:35]
    ds_read_b64_tr_b16 v[136:137], v14 offset:1216
    v_mfma_f32_16x16x32_bf16 v[36:39], v[72:75], v[104:107], v[36:39]
    ds_read_b64_tr_b16 v[138:139], v14 offset:1224
    v_mfma_f32_16x16x32_bf16 v[32:35], v[64:67], v[108:111], v[32:35]
    ds_read_b128 v[172:175], v15 offset:2240
    v_mfma_f32_16x16x32_bf16 v[36:39], v[68:71], v[108:111], v[36:39]
    ds_read_b64_tr_b16 v[140:141], v14 offset:1728
    v_mfma_f32_16x16x32_bf16 v[40:43], v[72:75], v[108:111], v[40:43]
    ds_read_b64_tr_b16 v[142:143], v14 offset:1736
    v_mfma_f32_16x16x32_bf16 v[32:35], v[76:79], v[96:99], v[32:35]
    ds_read_b128 v[176:179], v15 offset:1728
    v_mfma_f32_16x16x32_bf16 v[36:39], v[76:79], v[100:103], v[36:39]
    ds_read_b64_tr_b16 v[144:145], v14 offset:2240
    v_mfma_f32_16x16x32_bf16 v[40:43], v[76:79], v[104:107], v[40:43]
    ds_read_b64_tr_b16 v[146:147], v14 offset:2248
    v_mfma_f32_16x16x32_bf16 v[44:47], v[76:79], v[108:111], v[44:47]
    ds_read_b128 v[180:183], v15 offset:1216
    v_mfma_f32_16x16x32_bf16 v[36:39], v[64:67], v[112:115], v[36:39]
    ds_read_b64_tr_b16 v[148:149], v14 offset:2752
    v_mfma_f32_16x16x32_bf16 v[40:43], v[68:71], v[112:115], v[40:43]
    ds_read_b64_tr_b16 v[150:151], v14 offset:2760
    v_mfma_f32_16x16x32_bf16 v[44:47], v[72:75], v[112:115], v[44:47]
    ds_read_b128 v[184:187], v15 offset:704
    v_mfma_f32_16x16x32_bf16 v[48:51], v[76:79], v[112:115], v[48:51]
    ds_read_b64_tr_b16 v[152:153], v14 offset:3264
    v_mfma_f32_16x16x32_bf16 v[36:39], v[80:83], v[96:99], v[36:39]
    ds_read_b64_tr_b16 v[154:155], v14 offset:3272
    v_mfma_f32_16x16x32_bf16 v[40:43], v[80:83], v[100:103], v[40:43]
    ds_read_b128 v[188:191], v15 offset:192
    v_mfma_f32_16x16x32_bf16 v[44:47], v[80:83], v[104:107], v[44:47]
    ds_read_b64_tr_b16 v[156:157], v14 offset:3776
    v_mfma_f32_16x16x32_bf16 v[48:51], v[80:83], v[108:111], v[48:51]
    ds_read_b64_tr_b16 v[158:159], v14 offset:3784
    v_mfma_f32_16x16x32_bf16 v[40:43], v[64:67], v[116:119], v[40:43]
    v_mfma_f32_16x16x32_bf16 v[44:47], v[68:71], v[116:119], v[44:47]
    v_mfma_f32_16x16x32_bf16 v[48:51], v[72:75], v[116:119], v[48:51]
    v_mfma_f32_16x16x32_bf16 v[40:43], v[84:87], v[96:99], v[40:43]
    v_mfma_f32_16x16x32_bf16 v[44:47], v[84:87], v[100:103], v[44:47]
    v_mfma_f32_16x16x32_bf16 v[48:51], v[84:87], v[104:107], v[48:51]
    v_mfma_f32_16x16x32_bf16 v[44:47], v[64:67], v[120:123], v[44:47]
    v_mfma_f32_16x16x32_bf16 v[48:51], v[68:71], v[120:123], v[48:51]
    v_mfma_f32_16x16x32_bf16 v[44:47], v[88:91], v[96:99], v[44:47]
    v_mfma_f32_16x16x32_bf16 v[48:51], v[88:91], v[100:103], v[48:51]
    v_mfma_f32_16x16x32_bf16 v[48:51], v[64:67], v[124:127], v[48:51]
    v_mfma_f32_16x16x32_bf16 v[48:51], v[92:95], v[96:99], v[48:51]
    s_waitcnt lgkmcnt(0)
    v_lshlrev_b32 v18, 1, v5
    s_add_u32 s48, s15, 4088
    v_sub_u32 v18, s48, v18
    v_subrev_u32 v18, 1536, v18
    ds_read_b64 v[96:97], v18 offset:1536
    ds_read_b64 v[98:99], v18 offset:1024
    ds_read_b64 v[100:101], v18 offset:512
    ds_read_b64 v[102:103], v18 offset:0
    v_mfma_f32_16x16x32_bf16 v[20:23], v[128:131], v[160:163], v[20:23]
    v_lshlrev_b32 v64, 16, v200
    v_and_b32 v65, 0xffff0000, v200
    v_mfma_f32_16x16x32_bf16 v[24:27], v[128:131], v[164:167], v[24:27]
    v_lshlrev_b32 v66, 16, v201
    v_mfma_f32_16x16x32_bf16 v[24:27], v[132:135], v[160:163], v[24:27]
    v_and_b32 v67, 0xffff0000, v201
    v_mfma_f32_16x16x32_bf16 v[28:31], v[132:135], v[164:167], v[28:31]
    v_lshlrev_b32 v68, 16, v202
    v_and_b32 v69, 0xffff0000, v202
    v_mfma_f32_16x16x32_bf16 v[28:31], v[128:131], v[168:171], v[28:31]
    v_lshlrev_b32 v70, 16, v203
    v_mfma_f32_16x16x32_bf16 v[32:35], v[132:135], v[168:171], v[32:35]
    v_and_b32 v71, 0xffff0000, v203
    v_mfma_f32_16x16x32_bf16 v[28:31], v[136:139], v[160:163], v[28:31]
    v_lshlrev_b32 v72, 16, v204
    v_and_b32 v73, 0xffff0000, v204
    v_mfma_f32_16x16x32_bf16 v[32:35], v[136:139], v[164:167], v[32:35]
    v_lshlrev_b32 v74, 16, v205
    v_mfma_f32_16x16x32_bf16 v[36:39], v[136:139], v[168:171], v[36:39]
    v_and_b32 v75, 0xffff0000, v205
    v_mfma_f32_16x16x32_bf16 v[32:35], v[128:131], v[172:175], v[32:35]
    v_lshlrev_b32 v76, 16, v206
    v_and_b32 v77, 0xffff0000, v206
    v_mfma_f32_16x16x32_bf16 v[36:39], v[132:135], v[172:175], v[36:39]
    v_lshlrev_b32 v78, 16, v207
    v_mfma_f32_16x16x32_bf16 v[40:43], v[136:139], v[172:175], v[40:43]
    v_and_b32 v79, 0xffff0000, v207
    v_mfma_f32_16x16x32_bf16 v[32:35], v[140:143], v[160:163], v[32:35]
    v_fma_f32 v80, v64, v208, v212
    v_fma_f32 v81, v65, v209, v213
    v_fma_f32 v82, v66, v210, v214
    v_fma_f32 v83, v67, v211, v215
    v_mfma_f32_16x16x32_bf16 v[36:39], v[140:143], v[164:167], v[36:39]
    v_fma_f32 v84, v68, v216, v220
    v_fma_f32 v85, v69, v217, v221
    v_mfma_f32_16x16x32_bf16 v[40:43], v[140:143], v[168:171], v[40:43]
    v_fma_f32 v86, v70, v218, v222
    v_fma_f32 v87, v71, v219, v223
    v_mfma_f32_16x16x32_bf16 v[44:47], v[140:143], v[172:175], v[44:47]
    v_fma_f32 v88, v72, v224, v228
    v_fma_f32 v89, v73, v225, v229
    v_fma_f32 v90, v74, v226, v230
    v_fma_f32 v91, v75, v227, v231
    v_mfma_f32_16x16x32_bf16 v[36:39], v[128:131], v[176:179], v[36:39]
    v_fma_f32 v92, v76, v232, v236
    v_fma_f32 v93, v77, v233, v237
    v_mfma_f32_16x16x32_bf16 v[40:43], v[132:135], v[176:179], v[40:43]
    v_fma_f32 v94, v78, v234, v238
    v_fma_f32 v95, v79, v235, v239
    v_mfma_f32_16x16x32_bf16 v[44:47], v[136:139], v[176:179], v[44:47]
    s_waitcnt lgkmcnt(0)
    v_and_b32 v104, 0xffff0000, v97
    v_lshlrev_b32 v105, 16, v97
    v_mfma_f32_16x16x32_bf16 v[48:51], v[140:143], v[176:179], v[48:51]
    v_and_b32 v106, 0xffff0000, v96
    v_mfma_f32_16x16x32_bf16 v[36:39], v[144:147], v[160:163], v[36:39]
    v_lshlrev_b32 v107, 16, v96
    v_mfma_f32_16x16x32_bf16 v[40:43], v[144:147], v[164:167], v[40:43]
    v_and_b32 v108, 0xffff0000, v99
    v_lshlrev_b32 v109, 16, v99
    v_mfma_f32_16x16x32_bf16 v[44:47], v[144:147], v[168:171], v[44:47]
    v_and_b32 v110, 0xffff0000, v98
    v_mfma_f32_16x16x32_bf16 v[48:51], v[144:147], v[172:175], v[48:51]
    v_lshlrev_b32 v111, 16, v98
    v_mfma_f32_16x16x32_bf16 v[40:43], v[128:131], v[180:183], v[40:43]
    v_and_b32 v112, 0xffff0000, v101
    v_lshlrev_b32 v113, 16, v101
    v_mfma_f32_16x16x32_bf16 v[44:47], v[132:135], v[180:183], v[44:47]
    v_and_b32 v114, 0xffff0000, v100
    v_mfma_f32_16x16x32_bf16 v[48:51], v[136:139], v[180:183], v[48:51]
    v_lshlrev_b32 v115, 16, v100
    v_mfma_f32_16x16x32_bf16 v[40:43], v[148:151], v[160:163], v[40:43]
    v_and_b32 v116, 0xffff0000, v103
    v_lshlrev_b32 v117, 16, v103
    v_mfma_f32_16x16x32_bf16 v[44:47], v[148:151], v[164:167], v[44:47]
    v_and_b32 v118, 0xffff0000, v102
    v_mfma_f32_16x16x32_bf16 v[48:51], v[148:151], v[168:171], v[48:51]
    v_lshlrev_b32 v119, 16, v102
    v_mfma_f32_16x16x32_bf16 v[44:47], v[128:131], v[184:187], v[44:47]
    v_fma_f32 v80, v80, v242, v243
    v_fma_f32 v81, v81, v242, v243
    v_fma_f32 v82, v82, v242, v243
    v_fma_f32 v83, v83, v242, v243
    v_mfma_f32_16x16x32_bf16 v[48:51], v[132:135], v[184:187], v[48:51]
    v_fma_f32 v84, v84, v242, v243
    v_fma_f32 v85, v85, v242, v243
    v_mfma_f32_16x16x32_bf16 v[44:47], v[152:155], v[160:163], v[44:47]
    v_fma_f32 v86, v86, v242, v243
    v_fma_f32 v87, v87, v242, v243
    v_mfma_f32_16x16x32_bf16 v[48:51], v[152:155], v[164:167], v[48:51]
    v_fma_f32 v88, v88, v242, v243
    v_fma_f32 v89, v89, v242, v243
    v_fma_f32 v90, v90, v242, v243
    v_fma_f32 v91, v91, v242, v243
    v_mfma_f32_16x16x32_bf16 v[48:51], v[128:131], v[188:191], v[48:51]
    v_fma_f32 v92, v92, v242, v243
    v_fma_f32 v93, v93, v242, v243
    v_mfma_f32_16x16x32_bf16 v[48:51], v[156:159], v[160:163], v[48:51]
    v_fma_f32 v94, v94, v242, v243
    v_fma_f32 v95, v95, v242, v243
    s_nop 3
    s_cmp_eq_u32 s12, 0
    s_cbranch_scc0 PB_H1
    ds_write_b128 v16, v[36:39] offset:0
    ds_write_b128 v16, v[40:43] offset:1024
    ds_write_b128 v16, v[44:47] offset:2048
    ds_write_b128 v16, v[48:51] offset:3072
    s_branch PB_HX
PB_H1:
    ds_write_b128 v16, v[20:23] offset:0
    ds_write_b128 v16, v[24:27] offset:1024
    ds_write_b128 v16, v[28:31] offset:2048
    ds_write_b128 v16, v[32:35] offset:3072
    s_waitcnt lgkmcnt(0)
    v_mov_b32 v20, v36
    v_mov_b32 v21, v37
    v_mov_b32 v22, v38
    v_mov_b32 v23, v39
    v_mov_b32 v24, v40
    v_mov_b32 v25, v41
    v_mov_b32 v26, v42
    v_mov_b32 v27, v43
    v_mov_b32 v28, v44
    v_mov_b32 v29, v45
    v_mov_b32 v30, v46
    v_mov_b32 v31, v47
    v_mov_b32 v32, v48
    v_mov_b32 v33, v49
    v_mov_b32 v34, v50
    v_mov_b32 v35, v51
PB_HX:
    v_pk_fma_f32 v[20:21], v[104:105], v[240:241], v[20:21] op_sel_hi:[1,0,1]
    v_pk_fma_f32 v[22:23], v[106:107], v[240:241], v[22:23] op_sel_hi:[1,0,1]
    v_pk_fma_f32 v[24:25], v[108:109], v[240:241], v[24:25] op_sel_hi:[1,0,1]
    v_pk_fma_f32 v[26:27], v[110:111], v[240:241], v[26:27] op_sel_hi:[1,0,1]
    v_pk_fma_f32 v[28:29], v[112:113], v[240:241], v[28:29] op_sel_hi:[1,0,1]
    v_pk_fma_f32 v[30:31], v[114:115], v[240:241], v[30:31] op_sel_hi:[1,0,1]
    v_pk_fma_f32 v[32:33], v[116:117], v[240:241], v[32:33] op_sel_hi:[1,0,1]
    v_pk_fma_f32 v[34:35], v[118:119], v[240:241], v[34:35] op_sel_hi:[1,0,1]
    s_waitcnt lgkmcnt(0)
    s_lshl_b32 s68, s6, 2
    s_add_u32 s68, s68, 76800
    v_mov_b32 v250, s68
    v_mov_b32 v251, 1
    s_mov_b64 exec, 1
    ds_add_u32 v250, v251
    s_mov_b64 exec, -1
    s_mov_b32 s69, 200000
LW3:
    ds_read_b32 v251, v250
    s_waitcnt lgkmcnt(0)
    v_readfirstlane_b32 s68, v251
    s_cmp_ge_u32 s68, 2
    s_cbranch_scc1 LX3
    s_sub_u32 s69, s69, 1
    s_cbranch_scc0 LW3
LX3:
    ds_read_b128 v[128:131], v17 offset:0
    ds_read_b128 v[132:135], v17 offset:1024
    ds_read_b128 v[136:139], v17 offset:2048
    ds_read_b128 v[140:143], v17 offset:3072
    s_waitcnt lgkmcnt(3)
    v_pk_add_f32 v[20:21], v[20:21], v[128:129]
    v_pk_add_f32 v[22:23], v[22:23], v[130:131]
    v_pk_fma_f32 v[20:21], v[80:81], v[20:21], v[64:65]
    v_pk_fma_f32 v[22:23], v[82:83], v[22:23], v[66:67]
    v_cvt_pk_bf16_f32 v160, v20, v21
    v_cvt_pk_bf16_f32 v161, v22, v23
    v_lshlrev_b32 v104, 16, v160
    v_and_b32 v105, 0xffff0000, v160
    v_lshlrev_b32 v106, 16, v161
    v_and_b32 v107, 0xffff0000, v161
    v_pk_mul_f32 v[104:105], v[104:105], v[244:245] op_sel_hi:[1,0]
    v_pk_mul_f32 v[106:107], v[106:107], v[244:245] op_sel_hi:[1,0]
    v_cvt_pk_bf16_f32 v168, v104, v105
    v_cvt_pk_bf16_f32 v169, v106, v107
    s_waitcnt lgkmcnt(2)
    v_pk_add_f32 v[24:25], v[24:25], v[132:133]
    v_pk_add_f32 v[26:27], v[26:27], v[134:135]
    v_pk_fma_f32 v[24:25], v[84:85], v[24:25], v[68:69]
    v_pk_fma_f32 v[26:27], v[86:87], v[26:27], v[70:71]
    v_cvt_pk_bf16_f32 v162, v24, v25
    v_cvt_pk_bf16_f32 v163, v26, v27
    v_lshlrev_b32 v108, 16, v162
    v_and_b32 v109, 0xffff0000, v162
    v_lshlrev_b32 v110, 16, v163
    v_and_b32 v111, 0xffff0000, v163
    v_pk_mul_f32 v[108:109], v[108:109], v[244:245] op_sel_hi:[1,0]
    v_pk_mul_f32 v[110:111], v[110:111], v[244:245] op_sel_hi:[1,0]
    v_cvt_pk_bf16_f32 v170, v108, v109
    v_cvt_pk_bf16_f32 v171, v110, v111
    s_nop 1
    v_permlane16_swap_b32 v160, v162
    v_permlane16_swap_b32 v161, v163
    buffer_store_dwordx4 v[160:163], v9, s[44:47], s16 offen sc1
    s_nop 1
    v_permlane16_swap_b32 v168, v170
    v_permlane16_swap_b32 v169, v171
    buffer_store_dwordx4 v[168:171], v9, s[8:11], s16 offen sc1
    s_waitcnt lgkmcnt(1)
    v_pk_add_f32 v[28:29], v[28:29], v[136:137]
    v_pk_add_f32 v[30:31], v[30:31], v[138:139]
    v_pk_fma_f32 v[28:29], v[88:89], v[28:29], v[72:73]
    v_pk_fma_f32 v[30:31], v[90:91], v[30:31], v[74:75]
    v_cvt_pk_bf16_f32 v164, v28, v29
    v_cvt_pk_bf16_f32 v165, v30, v31
    v_lshlrev_b32 v112, 16, v164
    v_and_b32 v113, 0xffff0000, v164
    v_lshlrev_b32 v114, 16, v165
    v_and_b32 v115, 0xffff0000, v165
    v_pk_mul_f32 v[112:113], v[112:113], v[244:245] op_sel_hi:[1,0]
    v_pk_mul_f32 v[114:115], v[114:115], v[244:245] op_sel_hi:[1,0]
    v_cvt_pk_bf16_f32 v172, v112, v113
    v_cvt_pk_bf16_f32 v173, v114, v115
    s_waitcnt lgkmcnt(0)
    v_pk_add_f32 v[32:33], v[32:33], v[140:141]
    v_pk_add_f32 v[34:35], v[34:35], v[142:143]
    v_pk_fma_f32 v[32:33], v[92:93], v[32:33], v[76:77]
    v_pk_fma_f32 v[34:35], v[94:95], v[34:35], v[78:79]
    v_cvt_pk_bf16_f32 v166, v32, v33
    v_cvt_pk_bf16_f32 v167, v34, v35
    v_lshlrev_b32 v116, 16, v166
    v_and_b32 v117, 0xffff0000, v166
    v_lshlrev_b32 v118, 16, v167
    v_and_b32 v119, 0xffff0000, v167
    v_pk_mul_f32 v[116:117], v[116:117], v[244:245] op_sel_hi:[1,0]
    v_pk_mul_f32 v[118:119], v[118:119], v[244:245] op_sel_hi:[1,0]
    v_cvt_pk_bf16_f32 v174, v116, v117
    v_cvt_pk_bf16_f32 v175, v118, v119
    s_nop 1
    v_permlane16_swap_b32 v164, v166
    v_permlane16_swap_b32 v165, v167
    buffer_store_dwordx4 v[164:167], v9, s[44:47], s17 offen sc1
    s_nop 1
    v_permlane16_swap_b32 v172, v174
    v_permlane16_swap_b32 v173, v175
    buffer_store_dwordx4 v[172:175], v9, s[8:11], s17 offen sc1
    s_branch PB_END
PB_PREP:
    v_lshlrev_b32 v10, 4, v0
    s_waitcnt lgkmcnt(0)
    s_add_u32 s20, s4, 0x900000
    s_addc_u32 s21, s5, 0
    s_mov_b32 s22, 0x1c0000
    s_mov_b32 s23, 0x20000
    s_cmp_eq_u32 s3, 4
    s_cbranch_scc0 PB_PF
    s_barrier
    s_cmp_ge_u32 s2, 224
    s_cbranch_scc1 PB_IDLE
    s_barrier
    s_lshr_b32 s6, s2, 2
    s_and_b32 s7, s2, 3
    v_lshrrev_b32 v4, 5, v0
    v_lshlrev_b32 v9, 5, v4
    s_add_u32 s16, s4, 0x440000
    s_addc_u32 s17, s5, 0
    s_mov_b32 s18, 0xc000
    s_mov_b32 s19, 0x20000
    s_add_u32 s24, s4, 0x410000
    s_addc_u32 s25, s5, 0
    s_mov_b32 s26, 0x10000
    s_mov_b32 s27, 0x20000
    s_lshl_b32 s32, s6, 15
    s_lshl_b32 s33, s7, 13
    s_add_u32 s32, s32, s33
    s_add_u32 s33, s32, 4096
    buffer_load_dwordx4 v[16:19], v10, s[20:23], s32 offen offset:0 sc1
    buffer_load_dwordx4 v[20:23], v10, s[20:23], s32 offen offset:1024 sc1
    buffer_load_dwordx4 v[24:27], v10, s[20:23], s32 offen offset:2048 sc1
    buffer_load_dwordx4 v[28:31], v10, s[20:23], s32 offen offset:3072 sc1
    buffer_load_dwordx4 v[32:35], v10, s[20:23], s33 offen offset:0 sc1
    buffer_load_dwordx4 v[36:39], v10, s[20:23], s33 offen offset:1024 sc1
    buffer_load_dwordx4 v[40:43], v10, s[20:23], s33 offen offset:2048 sc1
    buffer_load_dwordx4 v[44:47], v10, s[20:23], s33 offen offset:3072 sc1
    v_lshlrev_b32 v8, 3, v0
    s_lshl_b32 s29, s7, 9
    s_add_u32 s30, s29, 8192
    s_add_u32 s31, s29, 6144
    buffer_load_dwordx2 v[64:65], v8, s[16:19], s30 offen sc1
    buffer_load_dwordx2 v[72:73], v8, s[16:19], s31 offen sc1
    s_add_u32 s30, s30, 12288
    s_add_u32 s31, s31, 12288
    buffer_load_dwordx2 v[66:67], v8, s[16:19], s30 offen sc1
    buffer_load_dwordx2 v[74:75], v8, s[16:19], s31 offen sc1
    s_add_u32 s30, s30, 12288
    s_add_u32 s31, s31, 12288
    buffer_load_dwordx2 v[68:69], v8, s[16:19], s30 offen sc1
    buffer_load_dwordx2 v[76:77], v8, s[16:19], s31 offen sc1
    s_add_u32 s30, s30, 12288
    s_add_u32 s31, s31, 12288
    buffer_load_dwordx2 v[70:71], v8, s[16:19], s30 offen sc1
    buffer_load_dwordx2 v[78:79], v8, s[16:19], s31 offen sc1
    s_add_u32 s30, s30, 12288
    s_add_u32 s31, s31, 12288
    v_mov_b32 v12, 0
    v_mov_b32 v13, 0
    v_mov_b32 v14, 0
    v_mov_b32 v15, 0
    s_waitcnt vmcnt(0)
    v_add_f32 v64, v64, v66
    v_add_f32 v68, v68, v70
    v_add_f32 v64, v64, v68
    v_cvt_pk_bf16_f32 v64, v64, v64
    v_and_b32 v64, 0xffff0000, v64
    v_add_f32 v65, v65, v67
    v_add_f32 v69, v69, v71
    v_add_f32 v65, v65, v69
    v_cvt_pk_bf16_f32 v65, v65, v65
    v_and_b32 v65, 0xffff0000, v65
    v_add_f32 v72, v72, v74
    v_add_f32 v76, v76, v78
    v_add_f32 v72, v72, v76
    v_cvt_pk_bf16_f32 v72, v72, v72
    v_and_b32 v72, 0xffff0000, v72
    v_add_f32 v73, v73, v75
    v_add_f32 v77, v77, v79
    v_add_f32 v73, v73, v77
    v_cvt_pk_bf16_f32 v73, v73, v73
    v_and_b32 v73, 0xffff0000, v73
    v_add_f32 v64, 1.0, v64
    v_cvt_pk_bf16_f32 v64, v64, v64
    v_and_b32 v64, 0xffff0000, v64
    v_add_f32 v65, 1.0, v65
    v_cvt_pk_bf16_f32 v65, v65, v65
    v_and_b32 v65, 0xffff0000, v65
    v_add_u32 v8, 58880, v8
    ds_write_b64 v8, v[64:65]
    ds_write_b64 v8, v[72:73] offset:512
    v_add_u32 v9, 58880, v9
    s_waitcnt lgkmcnt(0)
    ds_read_b128 v[64:67], v9 offset:0
    ds_read_b128 v[68:71], v9 offset:16
    ds_read_b128 v[72:75], v9 offset:512
    ds_read_b128 v[76:79], v9 offset:528
    ds_read_b128 v[80:83], v9 offset:64
    ds_read_b128 v[84:87], v9 offset:80
    ds_read_b128 v[88:91], v9 offset:576
    ds_read_b128 v[92:95], v9 offset:592
    ds_read_b128 v[96:99], v9 offset:128
    ds_read_b128 v[100:103], v9 offset:144
    ds_read_b128 v[104:107], v9 offset:640
    ds_read_b128 v[108:111], v9 offset:656
    s_waitcnt lgkmcnt(0)
    ds_read_b128 v[112:115], v9 offset:192
    ds_read_b128 v[116:119], v9 offset:208
    ds_read_b128 v[120:123], v9 offset:704
    ds_read_b128 v[124:127], v9 offset:720
    ds_read_b128 v[128:131], v9 offset:256
    ds_read_b128 v[132:135], v9 offset:272
    ds_read_b128 v[136:139], v9 offset:768
    ds_read_b128 v[140:143], v9 offset:784
    ds_read_b128 v[144:147], v9 offset:320
    ds_read_b128 v[148:151], v9 offset:336
    ds_read_b128 v[152:155], v9 offset:832
    ds_read_b128 v[156:159], v9 offset:848
    s_waitcnt lgkmcnt(0)
    ds_read_b128 v[160:163], v9 offset:384
    ds_read_b128 v[164:167], v9 offset:400
    ds_read_b128 v[168:171], v9 offset:896
    ds_read_b128 v[172:175], v9 offset:912
    ds_read_b128 v[176:179], v9 offset:448
    ds_read_b128 v[180:183], v9 offset:464
    ds_read_b128 v[184:187], v9 offset:960
    ds_read_b128 v[188:191], v9 offset:976
    s_waitcnt lgkmcnt(0)
    v_lshlrev_b32 v48, 16, v16
    v_and_b32 v49, 0xffff0000, v16
    v_lshlrev_b32 v50, 16, v17
    v_and_b32 v51, 0xffff0000, v17
    v_lshlrev_b32 v52, 16, v18
    v_and_b32 v53, 0xffff0000, v18
    v_lshlrev_b32 v54, 16, v19
    v_and_b32 v55, 0xffff0000, v19
    v_fmac_f32 v12, v48, v64
    v_fmac_f32 v14, v48, v72
    v_fmac_f32 v13, v49, v65
    v_fmac_f32 v15, v49, v73
    v_fmac_f32 v12, v50, v66
    v_fmac_f32 v14, v50, v74
    v_fmac_f32 v13, v51, v67
    v_fmac_f32 v15, v51, v75
    v_fmac_f32 v12, v52, v68
    v_fmac_f32 v14, v52, v76
    v_fmac_f32 v13, v53, v69
    v_fmac_f32 v15, v53, v77
    v_fmac_f32 v12, v54, v70
    v_fmac_f32 v14, v54, v78
    v_fmac_f32 v13, v55, v71
    v_fmac_f32 v15, v55, v79
    v_lshlrev_b32 v48, 16, v20
    v_and_b32 v49, 0xffff0000, v20
    v_lshlrev_b32 v50, 16, v21
    v_and_b32 v51, 0xffff0000, v21
    v_lshlrev_b32 v52, 16, v22
    v_and_b32 v53, 0xffff0000, v22
    v_lshlrev_b32 v54, 16, v23
    v_and_b32 v55, 0xffff0000, v23
    v_fmac_f32 v12, v48, v80
    v_fmac_f32 v14, v48, v88
    v_fmac_f32 v13, v49, v81
    v_fmac_f32 v15, v49, v89
    v_fmac_f32 v12, v50, v82
    v_fmac_f32 v14, v50, v90
    v_fmac_f32 v13, v51, v83
    v_fmac_f32 v15, v51, v91
    v_fmac_f32 v12, v52, v84
    v_fmac_f32 v14, v52, v92
    v_fmac_f32 v13, v53, v85
    v_fmac_f32 v15, v53, v93
    v_fmac_f32 v12, v54, v86
    v_fmac_f32 v14, v54, v94
    v_fmac_f32 v13, v55, v87
    v_fmac_f32 v15, v55, v95
    v_lshlrev_b32 v48, 16, v24
    v_and_b32 v49, 0xffff0000, v24
    v_lshlrev_b32 v50, 16, v25
    v_and_b32 v51, 0xffff0000, v25
    v_lshlrev_b32 v52, 16, v26
    v_and_b32 v53, 0xffff0000, v26
    v_lshlrev_b32 v54, 16, v27
    v_and_b32 v55, 0xffff0000, v27
    v_fmac_f32 v12, v48, v96
    v_fmac_f32 v14, v48, v104
    v_fmac_f32 v13, v49, v97
    v_fmac_f32 v15, v49, v105
    v_fmac_f32 v12, v50, v98
    v_fmac_f32 v14, v50, v106
    v_fmac_f32 v13, v51, v99
    v_fmac_f32 v15, v51, v107
    v_fmac_f32 v12, v52, v100
    v_fmac_f32 v14, v52, v108
    v_fmac_f32 v13, v53, v101
    v_fmac_f32 v15, v53, v109
    v_fmac_f32 v12, v54, v102
    v_fmac_f32 v14, v54, v110
    v_fmac_f32 v13, v55, v103
    v_fmac_f32 v15, v55, v111
    v_lshlrev_b32 v48, 16, v28
    v_and_b32 v49, 0xffff0000, v28
    v_lshlrev_b32 v50, 16, v29
    v_and_b32 v51, 0xffff0000, v29
    v_lshlrev_b32 v52, 16, v30
    v_and_b32 v53, 0xffff0000, v30
    v_lshlrev_b32 v54, 16, v31
    v_and_b32 v55, 0xffff0000, v31
    v_fmac_f32 v12, v48, v112
    v_fmac_f32 v14, v48, v120
    v_fmac_f32 v13, v49, v113
    v_fmac_f32 v15, v49, v121
    v_fmac_f32 v12, v50, v114
    v_fmac_f32 v14, v50, v122
    v_fmac_f32 v13, v51, v115
    v_fmac_f32 v15, v51, v123
    v_fmac_f32 v12, v52, v116
    v_fmac_f32 v14, v52, v124
    v_fmac_f32 v13, v53, v117
    v_fmac_f32 v15, v53, v125
    v_fmac_f32 v12, v54, v118
    v_fmac_f32 v14, v54, v126
    v_fmac_f32 v13, v55, v119
    v_fmac_f32 v15, v55, v127
    v_lshlrev_b32 v48, 16, v32
    v_and_b32 v49, 0xffff0000, v32
    v_lshlrev_b32 v50, 16, v33
    v_and_b32 v51, 0xffff0000, v33
    v_lshlrev_b32 v52, 16, v34
    v_and_b32 v53, 0xffff0000, v34
    v_lshlrev_b32 v54, 16, v35
    v_and_b32 v55, 0xffff0000, v35
    v_fmac_f32 v12, v48, v128
    v_fmac_f32 v14, v48, v136
    v_fmac_f32 v13, v49, v129
    v_fmac_f32 v15, v49, v137
    v_fmac_f32 v12, v50, v130
    v_fmac_f32 v14, v50, v138
    v_fmac_f32 v13, v51, v131
    v_fmac_f32 v15, v51, v139
    v_fmac_f32 v12, v52, v132
    v_fmac_f32 v14, v52, v140
    v_fmac_f32 v13, v53, v133
    v_fmac_f32 v15, v53, v141
    v_fmac_f32 v12, v54, v134
    v_fmac_f32 v14, v54, v142
    v_fmac_f32 v13, v55, v135
    v_fmac_f32 v15, v55, v143
    v_lshlrev_b32 v48, 16, v36
    v_and_b32 v49, 0xffff0000, v36
    v_lshlrev_b32 v50, 16, v37
    v_and_b32 v51, 0xffff0000, v37
    v_lshlrev_b32 v52, 16, v38
    v_and_b32 v53, 0xffff0000, v38
    v_lshlrev_b32 v54, 16, v39
    v_and_b32 v55, 0xffff0000, v39
    v_fmac_f32 v12, v48, v144
    v_fmac_f32 v14, v48, v152
    v_fmac_f32 v13, v49, v145
    v_fmac_f32 v15, v49, v153
    v_fmac_f32 v12, v50, v146
    v_fmac_f32 v14, v50, v154
    v_fmac_f32 v13, v51, v147
    v_fmac_f32 v15, v51, v155
    v_fmac_f32 v12, v52, v148
    v_fmac_f32 v14, v52, v156
    v_fmac_f32 v13, v53, v149
    v_fmac_f32 v15, v53, v157
    v_fmac_f32 v12, v54, v150
    v_fmac_f32 v14, v54, v158
    v_fmac_f32 v13, v55, v151
    v_fmac_f32 v15, v55, v159
    v_lshlrev_b32 v48, 16, v40
    v_and_b32 v49, 0xffff0000, v40
    v_lshlrev_b32 v50, 16, v41
    v_and_b32 v51, 0xffff0000, v41
    v_lshlrev_b32 v52, 16, v42
    v_and_b32 v53, 0xffff0000, v42
    v_lshlrev_b32 v54, 16, v43
    v_and_b32 v55, 0xffff0000, v43
    v_fmac_f32 v12, v48, v160
    v_fmac_f32 v14, v48, v168
    v_fmac_f32 v13, v49, v161
    v_fmac_f32 v15, v49, v169
    v_fmac_f32 v12, v50, v162
    v_fmac_f32 v14, v50, v170
    v_fmac_f32 v13, v51, v163
    v_fmac_f32 v15, v51, v171
    v_fmac_f32 v12, v52, v164
    v_fmac_f32 v14, v52, v172
    v_fmac_f32 v13, v53, v165
    v_fmac_f32 v15, v53, v173
    v_fmac_f32 v12, v54, v166
    v_fmac_f32 v14, v54, v174
    v_fmac_f32 v13, v55, v167
    v_fmac_f32 v15, v55, v175
    v_lshlrev_b32 v48, 16, v44
    v_and_b32 v49, 0xffff0000, v44
    v_lshlrev_b32 v50, 16, v45
    v_and_b32 v51, 0xffff0000, v45
    v_lshlrev_b32 v52, 16, v46
    v_and_b32 v53, 0xffff0000, v46
    v_lshlrev_b32 v54, 16, v47
    v_and_b32 v55, 0xffff0000, v47
    v_fmac_f32 v12, v48, v176
    v_fmac_f32 v14, v48, v184
    v_fmac_f32 v13, v49, v177
    v_fmac_f32 v15, v49, v185
    v_fmac_f32 v12, v50, v178
    v_fmac_f32 v14, v50, v186
    v_fmac_f32 v13, v51, v179
    v_fmac_f32 v15, v51, v187
    v_fmac_f32 v12, v52, v180
    v_fmac_f32 v14, v52, v188
    v_fmac_f32 v13, v53, v181
    v_fmac_f32 v15, v53, v189
    v_fmac_f32 v12, v54, v182
    v_fmac_f32 v14, v54, v190
    v_fmac_f32 v13, v55, v183
    v_fmac_f32 v15, v55, v191
    v_add_f32 v12, v12, v13
    v_add_f32 v13, v14, v15
    v_mov_b32 v14, v12
    v_mov_b32 v15, v13
    s_nop 1
    v_permlane32_swap_b32 v12, v14
    v_permlane32_swap_b32 v13, v15
    s_nop 1
    v_add_f32 v12, v12, v14
    v_add_f32 v13, v13, v15
    s_lshl_b32 s11, s7, 14
    s_lshl_b32 s33, s6, 7
    s_add_u32 s11, s11, s33
    s_add_u32 s33, s11, 8192
    v_lshlrev_b32 v14, 2, v0
    s_mov_b32 exec_hi, 0
    buffer_store_dword v12, v14, s[24:27], s11 offen sc1
    buffer_store_dword v13, v14, s[24:27], s33 offen sc1
    s_mov_b64 exec, -1
    s_branch PB_END
PB_PF:
    s_cmp_eq_u32 s3, 7
    s_cbranch_scc1 PB_W2X
    s_cmp_ge_u32 s2, 224
    s_cbranch_scc1 PB_W2X
    s_load_dwordx2 s[8:9], s[0:1], 64
    s_lshl_b32 s12, s2, 1
    s_add_u32 s12, s12, s3
    s_sub_u32 s12, s12, 5
    s_and_b32 s13, s12, 3
    s_lshr_b32 s12, s12, 2
    v_lshrrev_b32 v101, 4, v0
    v_and_b32 v102, 15, v0
    v_lshlrev_b32 v103, 2, v101
    v_xor_b32 v102, v102, v103
    v_lshlrev_b32 v102, 4, v102
    v_lshl_add_u32 v101, v101, 10, v102
    s_lshl_b32 s14, s13, 8
    v_add_u32 v101, s14, v101
    s_lshl_b32 s14, s12, 14
    s_sub_u32 s15, s3, 5
    s_lshl_b32 s15, s15, 12
    s_add_u32 s15, s15, 59904
    s_mov_b32 s16, s15
    s_waitcnt lgkmcnt(0)
    s_mov_b32 s28, s8
    s_mov_b32 s29, s9
    s_mov_b32 s30, 0x1c0000
    s_mov_b32 s31, 0x20000
    s_mov_b32 m0, s16
    s_add_u32 s16, s16, 1024
    buffer_load_dwordx4 v101, s[28:31], s14 offen  lds
    s_add_u32 s14, s14, 4096
    s_mov_b32 m0, s16
    s_add_u32 s16, s16, 1024
    buffer_load_dwordx4 v101, s[28:31], s14 offen  lds
    s_add_u32 s14, s14, 4096
    s_mov_b32 m0, s16
    s_add_u32 s16, s16, 1024
    buffer_load_dwordx4 v101, s[28:31], s14 offen  lds
    s_add_u32 s14, s14, 4096
    s_mov_b32 m0, s16
    s_add_u32 s16, s16, 1024
    buffer_load_dwordx4 v101, s[28:31], s14 offen  lds
    s_add_u32 s14, s14, 4096
PB_W2X:
    s_cmp_eq_u32 s3, 7
    s_cbranch_scc1 PB_RAWY
    s_load_dwordx2 s[8:9], s[0:1], 64
    v_lshrrev_b32 v101, 3, v0
    v_and_b32 v102, 7, v0
    v_bfe_u32 v103, v0, 4, 1
    v_lshlrev_b32 v103, 2, v103
    v_xor_b32 v102, v102, v103
    v_lshlrev_b32 v102, 4, v102
    v_lshl_add_u32 v101, v101, 10, v102
    s_lshr_b32 s46, s2, 5
    s_lshl_b32 s46, s46, 7
    s_sub_u32 s47, s3, 5
    s_waitcnt lgkmcnt(0)
    s_mov_b32 s28, s8
    s_mov_b32 s29, s9
    s_mov_b32 s30, 0x1c0000
    s_mov_b32 s31, 0x20000
    s_lshl_b32 s48, s47, 1
    s_add_u32 s48, s48, 0
    s_mul_i32 s49, s48, 20480
    s_add_u32 s49, s49, 77824
    s_mul_i32 s48, s48, 458752
    s_add_u32 s48, s48, 131072
    s_add_u32 s48, s48, s46
    s_mov_b32 m0, s49
    s_add_u32 s49, s49, 1024
    buffer_load_dwordx4 v101, s[28:31], s48 offen  lds
    s_add_u32 s48, s48, 8192
    s_mov_b32 m0, s49
    s_add_u32 s49, s49, 1024
    buffer_load_dwordx4 v101, s[28:31], s48 offen  lds
    s_add_u32 s48, s48, 8192
    s_mov_b32 m0, s49
    s_add_u32 s49, s49, 1024
    buffer_load_dwordx4 v101, s[28:31], s48 offen  lds
    s_add_u32 s48, s48, 8192
    s_mov_b32 m0, s49
    s_add_u32 s49, s49, 1024
    buffer_load_dwordx4 v101, s[28:31], s48 offen  lds
    s_add_u32 s48, s48, 8192
    s_mov_b32 m0, s49
    s_add_u32 s49, s49, 1024
    buffer_load_dwordx4 v101, s[28:31], s48 offen  lds
    s_add_u32 s48, s48, 8192
    s_mov_b32 m0, s49
    s_add_u32 s49, s49, 1024
    buffer_load_dwordx4 v101, s[28:31], s48 offen  lds
    s_add_u32 s48, s48, 8192
    s_mov_b32 m0, s49
    s_add_u32 s49, s49, 1024
    buffer_load_dwordx4 v101, s[28:31], s48 offen  lds
    s_add_u32 s48, s48, 8192
    s_mov_b32 m0, s49
    s_add_u32 s49, s49, 1024
    buffer_load_dwordx4 v101, s[28:31], s48 offen  lds
    s_add_u32 s48, s48, 8192
    s_mov_b32 m0, s49
    s_add_u32 s49, s49, 1024
    buffer_load_dwordx4 v101, s[28:31], s48 offen  lds
    s_add_u32 s48, s48, 8192
    s_mov_b32 m0, s49
    s_add_u32 s49, s49, 1024
    buffer_load_dwordx4 v101, s[28:31], s48 offen  lds
    s_add_u32 s48, s48, 8192
    s_mov_b32 m0, s49
    s_add_u32 s49, s49, 1024
    buffer_load_dwordx4 v101, s[28:31], s48 offen  lds
    s_add_u32 s48, s48, 8192
    s_mov_b32 m0, s49
    s_add_u32 s49, s49, 1024
    buffer_load_dwordx4 v101, s[28:31], s48 offen  lds
    s_add_u32 s48, s48, 8192
    s_mov_b32 m0, s49
    s_add_u32 s49, s49, 1024
    buffer_load_dwordx4 v101, s[28:31], s48 offen  lds
    s_add_u32 s48, s48, 8192
    s_mov_b32 m0, s49
    s_add_u32 s49, s49, 1024
    buffer_load_dwordx4 v101, s[28:31], s48 offen  lds
    s_add_u32 s48, s48, 8192
    s_mov_b32 m0, s49
    s_add_u32 s49, s49, 1024
    buffer_load_dwordx4 v101, s[28:31], s48 offen  lds
    s_add_u32 s48, s48, 8192
    s_mov_b32 m0, s49
    s_add_u32 s49, s49, 1024
    buffer_load_dwordx4 v101, s[28:31], s48 offen  lds
    s_add_u32 s48, s48, 8192
    s_mov_b32 m0, s49
    s_add_u32 s49, s49, 1024
    buffer_load_dwordx4 v101, s[28:31], s48 offen  lds
    s_add_u32 s48, s48, 8192
    s_mov_b32 m0, s49
    s_add_u32 s49, s49, 1024
    buffer_load_dwordx4 v101, s[28:31], s48 offen  lds
    s_add_u32 s48, s48, 8192
    s_mov_b32 m0, s49
    s_add_u32 s49, s49, 1024
    buffer_load_dwordx4 v101, s[28:31], s48 offen  lds
    s_add_u32 s48, s48, 8192
    s_mov_b32 m0, s49
    s_add_u32 s49, s49, 1024
    buffer_load_dwordx4 v101, s[28:31], s48 offen  lds
    s_add_u32 s48, s48, 8192
PB_RAWY:
    s_cmp_lg_u32 s3, 7
    s_cbranch_scc1 SYN4
    s_mov_b32 s69, 200000
    v_lshlrev_b32 v252, 8, v0
    s_mov_b64 exec, 0xff
    buffer_load_dword v253, v252, s[64:67], 0 offen offset:128 sc1
POL4:
    s_sleep 1
    buffer_load_dword v254, v252, s[64:67], 0 offen offset:128 sc1
    s_waitcnt vmcnt(1)
    v_cmp_eq_u32 vcc, 0, v253
    s_cmp_eq_u64 vcc, 0
    s_cbranch_scc1 GOT4
    s_sleep 1
    buffer_load_dword v253, v252, s[64:67], 0 offen offset:128 sc1
    s_waitcnt vmcnt(1)
    v_cmp_eq_u32 vcc, 0, v254
    s_cmp_eq_u64 vcc, 0
    s_cbranch_scc1 GOT4
    s_sub_u32 s69, s69, 1
    s_cbranch_scc0 POL4
GOT4:
    s_mov_b64 exec, -1
SYN4:
    s_barrier
    s_barrier
    s_cmp_eq_u32 s3, 7
    s_cbranch_scc1 PB_W2Y
    s_cmp_ge_u32 s2, 224
    s_cbranch_scc1 PB_W2Y
    s_add_u32 s28, s4, 0xb00000
    s_addc_u32 s29, s5, 0
    s_mov_b32 s30, 0x1c0000
    s_mov_b32 s31, 0x20000
    v_bfe_u32 v101, v0, 2, 2
    v_lshrrev_b32 v102, 5, v0
    v_lshl_add_u32 v102, v102, 2, v101
    v_lshlrev_b32 v102, 8, v102
    v_bfe_u32 v103, v0, 4, 1
    v_lshl_add_u32 v102, v103, 5, v102
    v_and_b32 v103, 3, v0
    v_lshl_add_u32 v102, v103, 3, v102
    v_add_u32 v102, s15, v102
    s_waitcnt vmcnt(20)
    v_xor_b32 v103, 0, v101
    v_lshl_add_u32 v103, v103, 6, v102
    ds_read_b64_tr_b16 v[104:105], v103
    ds_read_b64_tr_b16 v[106:107], v103 offset:2048
    v_xor_b32 v103, 1, v101
    v_lshl_add_u32 v103, v103, 6, v102
    ds_read_b64_tr_b16 v[108:109], v103
    ds_read_b64_tr_b16 v[110:111], v103 offset:2048
    v_xor_b32 v103, 2, v101
    v_lshl_add_u32 v103, v103, 6, v102
    ds_read_b64_tr_b16 v[112:113], v103
    ds_read_b64_tr_b16 v[114:115], v103 offset:2048
    v_xor_b32 v103, 3, v101
    v_lshl_add_u32 v103, v103, 6, v102
    ds_read_b64_tr_b16 v[116:117], v103
    ds_read_b64_tr_b16 v[118:119], v103 offset:2048
    s_mul_i32 s14, s13, 458752
    s_lshl_b32 s16, s12, 10
    s_add_u32 s14, s14, s16
    s_waitcnt lgkmcnt(0)
    buffer_store_dwordx4 v[104:107], v10, s[28:31], s14 offen sc1
    s_add_u32 s14, s14, 114688
    buffer_store_dwordx4 v[108:111], v10, s[28:31], s14 offen sc1
    s_add_u32 s14, s14, 114688
    buffer_store_dwordx4 v[112:115], v10, s[28:31], s14 offen sc1
    s_add_u32 s14, s14, 114688
    buffer_store_dwordx4 v[116:119], v10, s[28:31], s14 offen sc1
    s_add_u32 s14, s14, 114688
PB_W2Y:
    s_branch PB_NOZ
    s_cmp_lg_u32 s3, 7
    s_cbranch_scc1 PB_NOZ
    s_cmp_ge_u32 s2, 32
    s_cbranch_scc1 PB_NOZ
    s_add_u32 s24, s4, 0x430000
    s_addc_u32 s25, s5, 0
    s_mov_b32 s26, 0x1000
    s_mov_b32 s27, 0x20000
    s_lshl_b32 s6, s2, 7
    v_mov_b32 v12, 0
    s_mov_b64 exec, 1
    buffer_store_dword v12, off, s[24:27], s6 sc1
    s_mov_b64 exec, -1
PB_NOZ:
    s_cmp_eq_u32 s3, 7
    s_cbranch_scc1 PB_RAWX
    s_load_dwordx2 s[8:9], s[0:1], 64
    v_lshrrev_b32 v101, 3, v0
    v_and_b32 v102, 7, v0
    v_bfe_u32 v103, v0, 4, 1
    v_lshlrev_b32 v103, 2, v103
    v_xor_b32 v102, v102, v103
    v_lshlrev_b32 v102, 4, v102
    v_lshl_add_u32 v101, v101, 10, v102
    s_lshr_b32 s12, s2, 5
    s_lshl_b32 s12, s12, 7
    s_sub_u32 s13, s3, 5
    s_waitcnt lgkmcnt(0)
    s_mov_b32 s28, s8
    s_mov_b32 s29, s9
    s_mov_b32 s30, 0x1c0000
    s_mov_b32 s31, 0x20000
    s_lshl_b32 s14, s13, 1
    s_add_u32 s14, s14, 1
    s_mul_i32 s15, s14, 20480
    s_add_u32 s15, s15, 77824
    s_mul_i32 s14, s14, 458752
    s_add_u32 s14, s14, 131072
    s_add_u32 s14, s14, s12
    s_mov_b32 m0, s15
    s_add_u32 s15, s15, 1024
    buffer_load_dwordx4 v101, s[28:31], s14 offen  lds
    s_add_u32 s14, s14, 8192
    s_mov_b32 m0, s15
    s_add_u32 s15, s15, 1024
    buffer_load_dwordx4 v101, s[28:31], s14 offen  lds
    s_add_u32 s14, s14, 8192
    s_mov_b32 m0, s15
    s_add_u32 s15, s15, 1024
    buffer_load_dwordx4 v101, s[28:31], s14 offen  lds
    s_add_u32 s14, s14, 8192
    s_mov_b32 m0, s15
    s_add_u32 s15, s15, 1024
    buffer_load_dwordx4 v101, s[28:31], s14 offen  lds
    s_add_u32 s14, s14, 8192
    s_mov_b32 m0, s15
    s_add_u32 s15, s15, 1024
    buffer_load_dwordx4 v101, s[28:31], s14 offen  lds
    s_add_u32 s14, s14, 8192
    s_mov_b32 m0, s15
    s_add_u32 s15, s15, 1024
    buffer_load_dwordx4 v101, s[28:31], s14 offen  lds
    s_add_u32 s14, s14, 8192
    s_mov_b32 m0, s15
    s_add_u32 s15, s15, 1024
    buffer_load_dwordx4 v101, s[28:31], s14 offen  lds
    s_add_u32 s14, s14, 8192
    s_mov_b32 m0, s15
    s_add_u32 s15, s15, 1024
    buffer_load_dwordx4 v101, s[28:31], s14 offen  lds
    s_add_u32 s14, s14, 8192
    s_mov_b32 m0, s15
    s_add_u32 s15, s15, 1024
    buffer_load_dwordx4 v101, s[28:31], s14 offen  lds
    s_add_u32 s14, s14, 8192
    s_mov_b32 m0, s15
    s_add_u32 s15, s15, 1024
    buffer_load_dwordx4 v101, s[28:31], s14 offen  lds
    s_add_u32 s14, s14, 8192
    s_mov_b32 m0, s15
    s_add_u32 s15, s15, 1024
    buffer_load_dwordx4 v101, s[28:31], s14 offen  lds
    s_add_u32 s14, s14, 8192
    s_mov_b32 m0, s15
    s_add_u32 s15, s15, 1024
    buffer_load_dwordx4 v101, s[28:31], s14 offen  lds
    s_add_u32 s14, s14, 8192
    s_mov_b32 m0, s15
    s_add_u32 s15, s15, 1024
    buffer_load_dwordx4 v101, s[28:31], s14 offen  lds
    s_add_u32 s14, s14, 8192
    s_mov_b32 m0, s15
    s_add_u32 s15, s15, 1024
    buffer_load_dwordx4 v101, s[28:31], s14 offen  lds
    s_add_u32 s14, s14, 8192
    s_mov_b32 m0, s15
    s_add_u32 s15, s15, 1024
    buffer_load_dwordx4 v101, s[28:31], s14 offen  lds
    s_add_u32 s14, s14, 8192
    s_mov_b32 m0, s15
    s_add_u32 s15, s15, 1024
    buffer_load_dwordx4 v101, s[28:31], s14 offen  lds
    s_add_u32 s14, s14, 8192
    s_mov_b32 m0, s15
    s_add_u32 s15, s15, 1024
    buffer_load_dwordx4 v101, s[28:31], s14 offen  lds
    s_add_u32 s14, s14, 8192
    s_mov_b32 m0, s15
    s_add_u32 s15, s15, 1024
    buffer_load_dwordx4 v101, s[28:31], s14 offen  lds
    s_add_u32 s14, s14, 8192
    s_mov_b32 m0, s15
    s_add_u32 s15, s15, 1024
    buffer_load_dwordx4 v101, s[28:31], s14 offen  lds
    s_add_u32 s14, s14, 8192
    s_mov_b32 m0, s15
    s_add_u32 s15, s15, 1024
    buffer_load_dwordx4 v101, s[28:31], s14 offen  lds
    s_add_u32 s14, s14, 8192
PB_RAWX:
    s_cmp_lg_u32 s3, 6
    s_cbranch_scc1 PB_NOG
    s_cmp_ge_u32 s2, 8
    s_cbranch_scc1 PB_NOG
    s_add_u32 s16, s4, 0x440000
    s_addc_u32 s17, s5, 0
    s_mov_b32 s18, 0xc000
    s_mov_b32 s19, 0x20000
    s_add_u32 s24, s4, 0x404000
    s_addc_u32 s25, s5, 0
    s_mov_b32 s26, 0x3000
    s_mov_b32 s27, 0x20000
    v_lshlrev_b32 v12, 2, v0
    s_lshl_b32 s6, s2, 8
    s_add_u32 s6, s6, 10240
    s_mov_b32 s7, s6
    buffer_load_dword v13, v12, s[16:19], s7 offen sc1
    s_add_u32 s7, s7, 12288
    buffer_load_dword v14, v12, s[16:19], s7 offen sc1
    s_add_u32 s7, s7, 12288
    buffer_load_dword v15, v12, s[16:19], s7 offen sc1
    s_add_u32 s7, s7, 12288
    buffer_load_dword v16, v12, s[16:19], s7 offen sc1
    s_add_u32 s7, s7, 12288
    s_waitcnt vmcnt(0)
    v_add_f32 v13, v13, v14
    v_add_f32 v15, v15, v16
    v_add_f32 v13, v13, v15
    v_cvt_pk_bf16_f32 v13, v13, v13
    v_and_b32 v13, 0xffff0000, v13
    buffer_store_dword v13, v12, s[24:27], s6 offen sc1
PB_NOG:
    s_branch PB_END
PB_IDLE:
    s_barrier
PB_END:
    s_waitcnt vmcnt(0) lgkmcnt(0)
    s_barrier
    s_cmp_lg_u32 s3, 7
    s_cbranch_scc1 ARS5
    v_mov_b32 v1, 1
    s_mov_b64 exec, 1
    s_and_b32 s68, s2, 7
    s_lshl_b32 s68, s68, 8
    s_add_u32 s68, s68, 0x800
    buffer_atomic_add v1, off, s[64:67], s68 sc0 sc1
    s_mov_b64 exec, -1
ARS5:
    s_cmp_lg_u32 s3, 7
    s_cbranch_scc1 ARR5
    s_waitcnt vmcnt(0)
    v_readfirstlane_b32 s69, v1
    s_cmp_lg_u32 s69, 31
    s_cbranch_scc1 ARR5
    v_mov_b32 v1, 1
    s_mov_b64 exec, 1
    buffer_store_dword v1, off, s[64:67], s68 offset:128 sc1
    s_mov_b64 exec, -1
ARR5:
    s_cmp_ge_u32 s2, 224
    s_cbranch_scc1 PC_HELP
    s_and_b32 s11, s2, 31
    s_lshr_b32 s12, s2, 5
    s_lshl_b32 s13, s12, 3
    s_add_u32 s13, s13, s3
    v_lshrrev_b32 v2, 3, v0
    v_and_b32 v3, 7, v0
    v_bfe_u32 v4, v0, 4, 1
    v_lshlrev_b32 v4, 2, v4
    v_xor_b32 v3, v3, v4
    v_lshlrev_b32 v3, 4, v3
    v_lshl_add_u32 v3, v2, 12, v3
    s_lshl_b32 s14, s11, 7
    v_add_u32 v3, s14, v3
    v_lshlrev_b32 v4, 4, v0
    s_lshl_b32 s36, s3, 15
    s_lshl_b32 s37, s3, 10
    s_lshl_b32 s38, s13, 15
    s_and_b32 s15, s3, 3
    s_lshl_b32 s15, s15, 8
    s_lshl_b32 s40, s12, 10
    s_add_u32 s15, s15, s40
    s_lshr_b32 s40, s3, 2
    s_lshl_b32 s40, s40, 13
    s_add_u32 s15, s15, s40
    v_lshlrev_b32 v10, 2, v0
    s_waitcnt lgkmcnt(0)
    s_add_u32 s16, s4, 0x1500000
    s_addc_u32 s17, s5, 0
    s_mov_b32 s18, 0x200000
    s_mov_b32 s19, 0x20000
    s_add_u32 s20, s4, 0x900000
    s_addc_u32 s21, s5, 0
    s_mov_b32 s22, 0x1c0000
    s_mov_b32 s23, 0x20000
    s_add_u32 s24, s4, 0x410000
    s_addc_u32 s25, s5, 0
    s_mov_b32 s26, 0x10000
    s_mov_b32 s27, 0x20000
    v_bfe_u32 v5, v0, 2, 2
    v_and_b32 v6, 3, v0
    v_bfe_u32 v7, v0, 4, 1
    v_lshrrev_b32 v12, 5, v0
    v_lshlrev_b32 v13, 3, v12
    v_add_u32 v13, v13, v5
    v_lshlrev_b32 v13, 7, v13
    v_lshl_add_u32 v13, v7, 5, v13
    v_lshl_add_u32 v13, v6, 3, v13
    v_lshrrev_b32 v14, 1, v5
    s_lshr_b32 s39, s3, 2
    v_xor_b32 v14, s39, v14
    v_lshl_add_u32 v8, v14, 6, v13
    v_xor_b32 v9, 64, v8
    v_mov_b32 v64, 0
    v_mov_b32 v65, 0
    v_mov_b32 v66, 0
    v_mov_b32 v67, 0
    v_mov_b32 v68, 0
    v_mov_b32 v69, 0
    v_mov_b32 v70, 0
    v_mov_b32 v71, 0
    v_mov_b32 v72, 0
    v_mov_b32 v73, 0
    v_mov_b32 v74, 0
    v_mov_b32 v75, 0
    v_mov_b32 v76, 0
    v_mov_b32 v77, 0
    v_mov_b32 v78, 0
    v_mov_b32 v79, 0
    v_mov_b32 v80, 0
    v_mov_b32 v81, 0
    v_mov_b32 v82, 0
    v_mov_b32 v83, 0
    v_mov_b32 v84, 0
    v_mov_b32 v85, 0
    v_mov_b32 v86, 0
    v_mov_b32 v87, 0
    v_mov_b32 v88, 0
    v_mov_b32 v89, 0
    v_mov_b32 v90, 0
    v_mov_b32 v91, 0
    v_mov_b32 v92, 0
    v_mov_b32 v93, 0
    v_mov_b32 v94, 0
    v_mov_b32 v95, 0
    buffer_load_dwordx4 v[128:131], v4, s[20:23], s38 offen offset:0 sc1
    buffer_load_dwordx4 v[132:135], v4, s[20:23], s38 offen offset:1024 sc1
    buffer_load_dwordx4 v[136:139], v4, s[20:23], s38 offen offset:2048 sc1
    buffer_load_dwordx4 v[140:143], v4, s[20:23], s38 offen offset:3072 sc1
    s_add_u32 s38, s38, 4096
    buffer_load_dwordx4 v[144:147], v4, s[20:23], s38 offen offset:0 sc1
    buffer_load_dwordx4 v[148:151], v4, s[20:23], s38 offen offset:1024 sc1
    buffer_load_dwordx4 v[152:155], v4, s[20:23], s38 offen offset:2048 sc1
    buffer_load_dwordx4 v[156:159], v4, s[20:23], s38 offen offset:3072 sc1
    s_add_u32 s38, s38, 4096
    buffer_load_dwordx4 v[160:163], v4, s[20:23], s38 offen offset:0 sc1
    buffer_load_dwordx4 v[164:167], v4, s[20:23], s38 offen offset:1024 sc1
    buffer_load_dwordx4 v[168:171], v4, s[20:23], s38 offen offset:2048 sc1
    buffer_load_dwordx4 v[172:175], v4, s[20:23], s38 offen offset:3072 sc1
    s_add_u32 s38, s38, 4096
    buffer_load_dwordx4 v[176:179], v4, s[20:23], s38 offen offset:0 sc1
    buffer_load_dwordx4 v[180:183], v4, s[20:23], s38 offen offset:1024 sc1
    buffer_load_dwordx4 v[184:187], v4, s[20:23], s38 offen offset:2048 sc1
    buffer_load_dwordx4 v[188:191], v4, s[20:23], s38 offen offset:3072 sc1
    s_add_u32 s38, s38, 4096
    s_cmp_lg_u32 s3, 7
    s_cbranch_scc1 SYN6
    s_mov_b32 s69, 200000
    v_lshlrev_b32 v252, 8, v0
    s_mov_b64 exec, 0xff
    buffer_load_dword v253, v252, s[64:67], 0 offen offset:2176 sc1
POL6:
    s_sleep 1
    buffer_load_dword v254, v252, s[64:67], 0 offen offset:2176 sc1
    s_waitcnt vmcnt(1)
    v_cmp_eq_u32 vcc, 0, v253
    s_cmp_eq_u64 vcc, 0
    s_cbranch_scc1 GOT6
    s_sleep 1
    buffer_load_dword v253, v252, s[64:67], 0 offen offset:2176 sc1
    s_waitcnt vmcnt(1)
    v_cmp_eq_u32 vcc, 0, v254
    s_cmp_eq_u64 vcc, 0
    s_cbranch_scc1 GOT6
    s_sub_u32 s69, s69, 1
    s_cbranch_scc0 POL6
GOT6:
    s_mov_b64 exec, -1
SYN6:
    s_barrier
    s_mov_b32 m0, s37
    s_add_u32 s37, s37, 8192
    buffer_load_dwordx4 v3, s[16:19], s36 offen sc1 lds
    s_add_u32 s36, s36, 0x40000
    s_mov_b32 m0, s37
    s_add_u32 s37, s37, 8192
    buffer_load_dwordx4 v3, s[16:19], s36 offen sc1 lds
    s_add_u32 s36, s36, 0x40000
    s_mov_b32 m0, s37
    s_add_u32 s37, s37, 8192
    buffer_load_dwordx4 v3, s[16:19], s36 offen sc1 lds
    s_add_u32 s36, s36, 0x40000
    s_mov_b32 m0, s37
    s_add_u32 s37, s37, 8192
    buffer_load_dwordx4 v3, s[16:19], s36 offen sc1 lds
    s_add_u32 s36, s36, 0x40000
    buffer_load_dword v96, v10, s[24:27], s15 offen sc1
    s_add_u32 s15, s15, 16384
    buffer_load_dword v97, v10, s[24:27], s15 offen sc1
    s_add_u32 s15, s15, 16384
    buffer_load_dword v98, v10, s[24:27], s15 offen sc1
    s_add_u32 s15, s15, 16384
    buffer_load_dword v99, v10, s[24:27], s15 offen sc1
    s_add_u32 s15, s15, 16384
    s_mov_b32 m0, s37
    s_add_u32 s37, s37, 8192
    buffer_load_dwordx4 v3, s[16:19], s36 offen sc1 lds
    s_add_u32 s36, s36, 0x40000
    s_mov_b32 m0, s37
    s_add_u32 s37, s37, 8192
    buffer_load_dwordx4 v3, s[16:19], s36 offen sc1 lds
    s_add_u32 s36, s36, 0x40000
    s_mov_b32 m0, s37
    s_add_u32 s37, s37, 8192
    buffer_load_dwordx4 v3, s[16:19], s36 offen sc1 lds
    s_add_u32 s36, s36, 0x40000
    s_mov_b32 m0, s37
    s_add_u32 s37, s37, 8192
    buffer_load_dwordx4 v3, s[16:19], s36 offen sc1 lds
    s_add_u32 s36, s36, 0x40000
    s_add_u32 s28, s4, 0xd00000
    s_addc_u32 s29, s5, 0
    s_mov_b32 s30, 0x700000
    s_mov_b32 s31, 0x20000
    s_add_u32 s32, s4, 0x420000
    s_addc_u32 s33, s5, 0
    s_mov_b32 s34, 0x4000
    s_mov_b32 s35, 0x20000
    s_add_u32 s48, s4, 0x43a000
    s_addc_u32 s49, s5, 0
    s_mov_b32 s50, 0x1000
    s_mov_b32 s51, 0x20000
    s_waitcnt vmcnt(11)
    s_barrier
    s_cmp_lt_u32 s3, 4
    s_cbranch_scc1 PC_NOPRIO
    s_setprio 1
PC_NOPRIO:
    ds_read_b64_tr_b16 v[16:17], v8 offset:0
    ds_read_b64_tr_b16 v[18:19], v8 offset:512
    ds_read_b64_tr_b16 v[20:21], v9 offset:0
    ds_read_b64_tr_b16 v[22:23], v9 offset:512
    ds_read_b64_tr_b16 v[24:25], v8 offset:2048
    ds_read_b64_tr_b16 v[26:27], v8 offset:2560
    ds_read_b64_tr_b16 v[28:29], v9 offset:2048
    ds_read_b64_tr_b16 v[30:31], v9 offset:2560
    s_waitcnt vmcnt(27) lgkmcnt(4)
    v_mfma_f32_32x32x16_bf16 v[64:79], v[128:131], v[16:19], v[64:79]
    ds_read_b64_tr_b16 v[32:33], v8 offset:4096
    ds_read_b64_tr_b16 v[34:35], v8 offset:4608
    v_mfma_f32_32x32x16_bf16 v[80:95], v[128:131], v[20:23], v[80:95]
    ds_read_b64_tr_b16 v[36:37], v9 offset:4096
    ds_read_b64_tr_b16 v[38:39], v9 offset:4608
    buffer_load_dwordx4 v[192:195], v4, s[20:23], s38 offen offset:0 sc1
    s_waitcnt vmcnt(27) lgkmcnt(4)
    v_mfma_f32_32x32x16_bf16 v[64:79], v[132:135], v[24:27], v[64:79]
    ds_read_b64_tr_b16 v[16:17], v8 offset:6144
    ds_read_b64_tr_b16 v[18:19], v8 offset:6656
    v_mfma_f32_32x32x16_bf16 v[80:95], v[132:135], v[28:31], v[80:95]
    ds_read_b64_tr_b16 v[20:21], v9 offset:6144
    ds_read_b64_tr_b16 v[22:23], v9 offset:6656
    buffer_load_dwordx4 v[196:199], v4, s[20:23], s38 offen offset:1024 sc1
    s_waitcnt vmcnt(12) lgkmcnt(4)
    s_barrier
    v_mfma_f32_32x32x16_bf16 v[64:79], v[136:139], v[32:35], v[64:79]
    ds_read_b64_tr_b16 v[24:25], v8 offset:8192
    ds_read_b64_tr_b16 v[26:27], v8 offset:8704
    v_mfma_f32_32x32x16_bf16 v[80:95], v[136:139], v[36:39], v[80:95]
    ds_read_b64_tr_b16 v[28:29], v9 offset:8192
    ds_read_b64_tr_b16 v[30:31], v9 offset:8704
    buffer_load_dwordx4 v[200:203], v4, s[20:23], s38 offen offset:2048 sc1
    s_waitcnt vmcnt(27) lgkmcnt(4)
    v_mfma_f32_32x32x16_bf16 v[64:79], v[140:143], v[16:19], v[64:79]
    ds_read_b64_tr_b16 v[32:33], v8 offset:10240
    ds_read_b64_tr_b16 v[34:35], v8 offset:10752
    v_mfma_f32_32x32x16_bf16 v[80:95], v[140:143], v[20:23], v[80:95]
    ds_read_b64_tr_b16 v[36:37], v9 offset:10240
    ds_read_b64_tr_b16 v[38:39], v9 offset:10752
    buffer_load_dwordx4 v[204:207], v4, s[20:23], s38 offen offset:3072 sc1
    s_add_u32 s38, s38, 4096
    s_waitcnt vmcnt(27) lgkmcnt(4)
    v_mfma_f32_32x32x16_bf16 v[64:79], v[144:147], v[24:27], v[64:79]
    ds_read_b64_tr_b16 v[16:17], v8 offset:12288
    ds_read_b64_tr_b16 v[18:19], v8 offset:12800
    v_mfma_f32_32x32x16_bf16 v[80:95], v[144:147], v[28:31], v[80:95]
    ds_read_b64_tr_b16 v[20:21], v9 offset:12288
    ds_read_b64_tr_b16 v[22:23], v9 offset:12800
    buffer_load_dwordx4 v[208:211], v4, s[20:23], s38 offen offset:0 sc1
    s_waitcnt vmcnt(27) lgkmcnt(4)
    v_mfma_f32_32x32x16_bf16 v[64:79], v[148:151], v[32:35], v[64:79]
    ds_read_b64_tr_b16 v[24:25], v8 offset:14336
    ds_read_b64_tr_b16 v[26:27], v8 offset:14848
    v_mfma_f32_32x32x16_bf16 v[80:95], v[148:151], v[36:39], v[80:95]
    ds_read_b64_tr_b16 v[28:29], v9 offset:14336
    ds_read_b64_tr_b16 v[30:31], v9 offset:14848
    buffer_load_dwordx4 v[212:215], v4, s[20:23], s38 offen offset:1024 sc1
    s_waitcnt vmcnt(14) lgkmcnt(4)
    s_barrier
    v_mfma_f32_32x32x16_bf16 v[64:79], v[152:155], v[16:19], v[64:79]
    ds_read_b64_tr_b16 v[32:33], v8 offset:16384
    ds_read_b64_tr_b16 v[34:35], v8 offset:16896
    v_mfma_f32_32x32x16_bf16 v[80:95], v[152:155], v[20:23], v[80:95]
    ds_read_b64_tr_b16 v[36:37], v9 offset:16384
    ds_read_b64_tr_b16 v[38:39], v9 offset:16896
    buffer_load_dwordx4 v[216:219], v4, s[20:23], s38 offen offset:2048 sc1
    s_waitcnt vmcnt(27) lgkmcnt(4)
    v_mfma_f32_32x32x16_bf16 v[64:79], v[156:159], v[24:27], v[64:79]
    ds_read_b64_tr_b16 v[16:17], v8 offset:18432
    ds_read_b64_tr_b16 v[18:19], v8 offset:18944
    v_mfma_f32_32x32x16_bf16 v[80:95], v[156:159], v[28:31], v[80:95]
    ds_read_b64_tr_b16 v[20:21], v9 offset:18432
    ds_read_b64_tr_b16 v[22:23], v9 offset:18944
    buffer_load_dwordx4 v[220:223], v4, s[20:23], s38 offen offset:3072 sc1
    s_add_u32 s38, s38, 4096
    s_waitcnt vmcnt(27) lgkmcnt(4)
    v_mfma_f32_32x32x16_bf16 v[64:79], v[160:163], v[32:35], v[64:79]
    ds_read_b64_tr_b16 v[24:25], v8 offset:20480
    ds_read_b64_tr_b16 v[26:27], v8 offset:20992
    v_mfma_f32_32x32x16_bf16 v[80:95], v[160:163], v[36:39], v[80:95]
    ds_read_b64_tr_b16 v[28:29], v9 offset:20480
    ds_read_b64_tr_b16 v[30:31], v9 offset:20992
    buffer_load_dwordx4 v[224:227], v4, s[20:23], s38 offen offset:0 sc1
    s_waitcnt vmcnt(27) lgkmcnt(4)
    v_mfma_f32_32x32x16_bf16 v[64:79], v[164:167], v[16:19], v[64:79]
    ds_read_b64_tr_b16 v[32:33], v8 offset:22528
    ds_read_b64_tr_b16 v[34:35], v8 offset:23040
    v_mfma_f32_32x32x16_bf16 v[80:95], v[164:167], v[20:23], v[80:95]
    ds_read_b64_tr_b16 v[36:37], v9 offset:22528
    ds_read_b64_tr_b16 v[38:39], v9 offset:23040
    buffer_load_dwordx4 v[228:231], v4, s[20:23], s38 offen offset:1024 sc1
    s_waitcnt vmcnt(27) lgkmcnt(4)
    s_waitcnt vmcnt(14)
    v_add_f32 v96, v96, v97
    v_add_f32 v98, v98, v99
    v_add_f32 v96, v96, v98
    s_lshl_b32 s15, s3, 8
    s_add_u32 s15, s15, 73728
    v_add_u32 v97, s15, v10
    ds_write_b32 v97, v96
    s_waitcnt lgkmcnt(0)
    v_mfma_f32_32x32x16_bf16 v[64:79], v[168:171], v[24:27], v[64:79]
    ds_read_b64_tr_b16 v[16:17], v8 offset:24576
    ds_read_b64_tr_b16 v[18:19], v8 offset:25088
    v_mfma_f32_32x32x16_bf16 v[80:95], v[168:171], v[28:31], v[80:95]
    ds_read_b64_tr_b16 v[20:21], v9 offset:24576
    ds_read_b64_tr_b16 v[22:23], v9 offset:25088
    buffer_load_dwordx4 v[232:235], v4, s[20:23], s38 offen offset:2048 sc1
    s_waitcnt vmcnt(27) lgkmcnt(4)
    v_mfma_f32_32x32x16_bf16 v[64:79], v[172:175], v[32:35], v[64:79]
    ds_read_b64_tr_b16 v[24:25], v8 offset:26624
    ds_read_b64_tr_b16 v[26:27], v8 offset:27136
    v_mfma_f32_32x32x16_bf16 v[80:95], v[172:175], v[36:39], v[80:95]
    ds_read_b64_tr_b16 v[28:29], v9 offset:26624
    ds_read_b64_tr_b16 v[30:31], v9 offset:27136
    buffer_load_dwordx4 v[236:239], v4, s[20:23], s38 offen offset:3072 sc1
    s_add_u32 s38, s38, 4096
    s_waitcnt vmcnt(27) lgkmcnt(4)
    v_mfma_f32_32x32x16_bf16 v[64:79], v[176:179], v[16:19], v[64:79]
    ds_read_b64_tr_b16 v[32:33], v8 offset:28672
    ds_read_b64_tr_b16 v[34:35], v8 offset:29184
    v_mfma_f32_32x32x16_bf16 v[80:95], v[176:179], v[20:23], v[80:95]
    ds_read_b64_tr_b16 v[36:37], v9 offset:28672
    ds_read_b64_tr_b16 v[38:39], v9 offset:29184
    buffer_load_dwordx4 v[240:243], v4, s[20:23], s38 offen offset:0 sc1
    s_waitcnt vmcnt(27) lgkmcnt(4)
    v_mfma_f32_32x32x16_bf16 v[64:79], v[180:183], v[24:27], v[64:79]
    ds_read_b64_tr_b16 v[16:17], v8 offset:30720
    ds_read_b64_tr_b16 v[18:19], v8 offset:31232
    v_mfma_f32_32x32x16_bf16 v[80:95], v[180:183], v[28:31], v[80:95]
    ds_read_b64_tr_b16 v[20:21], v9 offset:30720
    ds_read_b64_tr_b16 v[22:23], v9 offset:31232
    buffer_load_dwordx4 v[244:247], v4, s[20:23], s38 offen offset:1024 sc1
    s_waitcnt vmcnt(14) lgkmcnt(4)
    s_barrier
    v_mfma_f32_32x32x16_bf16 v[64:79], v[184:187], v[32:35], v[64:79]
    ds_read_b64_tr_b16 v[24:25], v8 offset:32768
    ds_read_b64_tr_b16 v[26:27], v8 offset:33280
    v_mfma_f32_32x32x16_bf16 v[80:95], v[184:187], v[36:39], v[80:95]
    ds_read_b64_tr_b16 v[28:29], v9 offset:32768
    ds_read_b64_tr_b16 v[30:31], v9 offset:33280
    buffer_load_dwordx4 v[248:251], v4, s[20:23], s38 offen offset:2048 sc1
    s_waitcnt vmcnt(27) lgkmcnt(4)
    v_mfma_f32_32x32x16_bf16 v[64:79], v[188:191], v[16:19], v[64:79]
    ds_read_b64_tr_b16 v[32:33], v8 offset:34816
    ds_read_b64_tr_b16 v[34:35], v8 offset:35328
    v_mfma_f32_32x32x16_bf16 v[80:95], v[188:191], v[20:23], v[80:95]
    ds_read_b64_tr_b16 v[36:37], v9 offset:34816
    ds_read_b64_tr_b16 v[38:39], v9 offset:35328
    buffer_load_dwordx4 v[252:255], v4, s[20:23], s38 offen offset:3072 sc1
    s_add_u32 s38, s38, 4096
    s_waitcnt vmcnt(15) lgkmcnt(4)
    v_mfma_f32_32x32x16_bf16 v[64:79], v[192:195], v[24:27], v[64:79]
    ds_read_b64_tr_b16 v[16:17], v8 offset:36864
    ds_read_b64_tr_b16 v[18:19], v8 offset:37376
    v_mfma_f32_32x32x16_bf16 v[80:95], v[192:195], v[28:31], v[80:95]
    ds_read_b64_tr_b16 v[20:21], v9 offset:36864
    ds_read_b64_tr_b16 v[22:23], v9 offset:37376
    s_waitcnt vmcnt(14) lgkmcnt(4)
    v_mfma_f32_32x32x16_bf16 v[64:79], v[196:199], v[32:35], v[64:79]
    ds_read_b64_tr_b16 v[24:25], v8 offset:38912
    ds_read_b64_tr_b16 v[26:27], v8 offset:39424
    v_mfma_f32_32x32x16_bf16 v[80:95], v[196:199], v[36:39], v[80:95]
    ds_read_b64_tr_b16 v[28:29], v9 offset:38912
    ds_read_b64_tr_b16 v[30:31], v9 offset:39424
    s_waitcnt vmcnt(13) lgkmcnt(4)
    v_mfma_f32_32x32x16_bf16 v[64:79], v[200:203], v[16:19], v[64:79]
    ds_read_b64_tr_b16 v[32:33], v8 offset:40960
    ds_read_b64_tr_b16 v[34:35], v8 offset:41472
    v_mfma_f32_32x32x16_bf16 v[80:95], v[200:203], v[20:23], v[80:95]
    ds_read_b64_tr_b16 v[36:37], v9 offset:40960
    ds_read_b64_tr_b16 v[38:39], v9 offset:41472
    s_waitcnt vmcnt(12) lgkmcnt(4)
    v_mfma_f32_32x32x16_bf16 v[64:79], v[204:207], v[24:27], v[64:79]
    ds_read_b64_tr_b16 v[16:17], v8 offset:43008
    ds_read_b64_tr_b16 v[18:19], v8 offset:43520
    v_mfma_f32_32x32x16_bf16 v[80:95], v[204:207], v[28:31], v[80:95]
    ds_read_b64_tr_b16 v[20:21], v9 offset:43008
    ds_read_b64_tr_b16 v[22:23], v9 offset:43520
    s_waitcnt vmcnt(11) lgkmcnt(4)
    v_mfma_f32_32x32x16_bf16 v[64:79], v[208:211], v[32:35], v[64:79]
    ds_read_b64_tr_b16 v[24:25], v8 offset:45056
    ds_read_b64_tr_b16 v[26:27], v8 offset:45568
    v_mfma_f32_32x32x16_bf16 v[80:95], v[208:211], v[36:39], v[80:95]
    ds_read_b64_tr_b16 v[28:29], v9 offset:45056
    ds_read_b64_tr_b16 v[30:31], v9 offset:45568
    s_waitcnt vmcnt(10) lgkmcnt(4)
    v_mfma_f32_32x32x16_bf16 v[64:79], v[212:215], v[16:19], v[64:79]
    ds_read_b64_tr_b16 v[32:33], v8 offset:47104
    ds_read_b64_tr_b16 v[34:35], v8 offset:47616
    v_mfma_f32_32x32x16_bf16 v[80:95], v[212:215], v[20:23], v[80:95]
    ds_read_b64_tr_b16 v[36:37], v9 offset:47104
    ds_read_b64_tr_b16 v[38:39], v9 offset:47616
    s_waitcnt vmcnt(9) lgkmcnt(4)
    v_mfma_f32_32x32x16_bf16 v[64:79], v[216:219], v[24:27], v[64:79]
    ds_read_b64_tr_b16 v[16:17], v8 offset:49152
    ds_read_b64_tr_b16 v[18:19], v8 offset:49664
    v_mfma_f32_32x32x16_bf16 v[80:95], v[216:219], v[28:31], v[80:95]
    ds_read_b64_tr_b16 v[20:21], v9 offset:49152
    ds_read_b64_tr_b16 v[22:23], v9 offset:49664
    s_waitcnt vmcnt(8) lgkmcnt(4)
    v_mfma_f32_32x32x16_bf16 v[64:79], v[220:223], v[32:35], v[64:79]
    ds_read_b64_tr_b16 v[24:25], v8 offset:51200
    ds_read_b64_tr_b16 v[26:27], v8 offset:51712
    v_mfma_f32_32x32x16_bf16 v[80:95], v[220:223], v[36:39], v[80:95]
    ds_read_b64_tr_b16 v[28:29], v9 offset:51200
    ds_read_b64_tr_b16 v[30:31], v9 offset:51712
    s_waitcnt vmcnt(7) lgkmcnt(4)
    v_mfma_f32_32x32x16_bf16 v[64:79], v[224:227], v[16:19], v[64:79]
    ds_read_b64_tr_b16 v[32:33], v8 offset:53248
    ds_read_b64_tr_b16 v[34:35], v8 offset:53760
    v_mfma_f32_32x32x16_bf16 v[80:95], v[224:227], v[20:23], v[80:95]
    ds_read_b64_tr_b16 v[36:37], v9 offset:53248
    ds_read_b64_tr_b16 v[38:39], v9 offset:53760
    s_waitcnt vmcnt(6) lgkmcnt(4)
    v_mfma_f32_32x32x16_bf16 v[64:79], v[228:231], v[24:27], v[64:79]
    ds_read_b64_tr_b16 v[16:17], v8 offset:55296
    ds_read_b64_tr_b16 v[18:19], v8 offset:55808
    v_mfma_f32_32x32x16_bf16 v[80:95], v[228:231], v[28:31], v[80:95]
    ds_read_b64_tr_b16 v[20:21], v9 offset:55296
    ds_read_b64_tr_b16 v[22:23], v9 offset:55808
    s_waitcnt vmcnt(5) lgkmcnt(4)
    v_mfma_f32_32x32x16_bf16 v[64:79], v[232:235], v[32:35], v[64:79]
    ds_read_b64_tr_b16 v[24:25], v8 offset:57344
    ds_read_b64_tr_b16 v[26:27], v8 offset:57856
    v_mfma_f32_32x32x16_bf16 v[80:95], v[232:235], v[36:39], v[80:95]
    ds_read_b64_tr_b16 v[28:29], v9 offset:57344
    ds_read_b64_tr_b16 v[30:31], v9 offset:57856
    v_and_b32 v15, 31, v0
    s_lshl_b32 s15, s11, 6
    s_lshr_b32 s41, s3, 2
    s_lshl_b32 s41, s41, 5
    s_add_u32 s15, s15, s41
    v_add_u32 v15, s15, v15
    v_lshlrev_b32 v15, 3, v15
    v_xor_b32 v11, 0x100, v15
    buffer_load_dwordx2 v[104:105], v15, s[32:35], 0 offen sc1
    buffer_load_dwordx2 v[106:107], v11, s[32:35], 0 offen sc1
    s_waitcnt vmcnt(6) lgkmcnt(4)
    v_mfma_f32_32x32x16_bf16 v[64:79], v[236:239], v[16:19], v[64:79]
    ds_read_b64_tr_b16 v[32:33], v8 offset:59392
    ds_read_b64_tr_b16 v[34:35], v8 offset:59904
    v_mfma_f32_32x32x16_bf16 v[80:95], v[236:239], v[20:23], v[80:95]
    ds_read_b64_tr_b16 v[36:37], v9 offset:59392
    ds_read_b64_tr_b16 v[38:39], v9 offset:59904
    s_waitcnt vmcnt(5) lgkmcnt(4)
    v_mfma_f32_32x32x16_bf16 v[64:79], v[240:243], v[24:27], v[64:79]
    ds_read_b64_tr_b16 v[16:17], v8 offset:61440
    ds_read_b64_tr_b16 v[18:19], v8 offset:61952
    v_mfma_f32_32x32x16_bf16 v[80:95], v[240:243], v[28:31], v[80:95]
    ds_read_b64_tr_b16 v[20:21], v9 offset:61440
    ds_read_b64_tr_b16 v[22:23], v9 offset:61952
    s_waitcnt vmcnt(4) lgkmcnt(4)
    v_mfma_f32_32x32x16_bf16 v[64:79], v[244:247], v[32:35], v[64:79]
    ds_read_b64_tr_b16 v[24:25], v8 offset:63488
    ds_read_b64_tr_b16 v[26:27], v8 offset:64000
    v_mfma_f32_32x32x16_bf16 v[80:95], v[244:247], v[36:39], v[80:95]
    ds_read_b64_tr_b16 v[28:29], v9 offset:63488
    ds_read_b64_tr_b16 v[30:31], v9 offset:64000
    s_lshl_b32 s15, s3, 7
    s_add_u32 s15, s15, 73728
    v_lshlrev_b32 v14, 4, v12
    v_add_u32 v14, s15, v14
    ds_read_b128 v[160:163], v14 offset:0
    ds_read_b128 v[176:179], v14 offset:1024
    ds_read_b128 v[164:167], v14 offset:32
    ds_read_b128 v[180:183], v14 offset:1056
    ds_read_b128 v[168:171], v14 offset:64
    ds_read_b128 v[184:187], v14 offset:1088
    ds_read_b128 v[172:175], v14 offset:96
    ds_read_b128 v[188:191], v14 offset:1120
    s_waitcnt vmcnt(3) lgkmcnt(12)
    v_mfma_f32_32x32x16_bf16 v[64:79], v[248:251], v[16:19], v[64:79]
    v_mfma_f32_32x32x16_bf16 v[80:95], v[248:251], v[20:23], v[80:95]
    s_waitcnt vmcnt(2) lgkmcnt(8)
    v_mfma_f32_32x32x16_bf16 v[64:79], v[252:255], v[24:27], v[64:79]
    v_mfma_f32_32x32x16_bf16 v[80:95], v[252:255], v[28:31], v[80:95]
    s_waitcnt vmcnt(0) lgkmcnt(0)
    s_mov_b32 s42, 200000
PC_GP:
    v_cmp_eq_u32 vcc, 0, v104
    v_cmp_eq_u32 s[46:47], 0, v106
    s_nop 1
    s_or_b64 vcc, vcc, s[46:47]
    s_cbranch_scc0 PC_GG
    s_sub_u32 s42, s42, 1
    s_cbranch_scc1 PC_GG
    s_sleep 2
    buffer_load_dwordx2 v[104:105], v15, s[32:35], 0 offen sc1
    buffer_load_dwordx2 v[106:107], v11, s[32:35], 0 offen sc1
    s_waitcnt vmcnt(0)
    s_branch PC_GP
PC_GG:
    v_fma_f32 v64, -v105, v160, v64
    v_fma_f32 v65, -v105, v161, v65
    v_fma_f32 v66, -v105, v162, v66
    v_fma_f32 v67, -v105, v163, v67
    v_fma_f32 v68, -v105, v164, v68
    v_fma_f32 v69, -v105, v165, v69
    v_fma_f32 v70, -v105, v166, v70
    v_fma_f32 v71, -v105, v167, v71
    v_fma_f32 v72, -v105, v168, v72
    v_fma_f32 v73, -v105, v169, v73
    v_fma_f32 v74, -v105, v170, v74
    v_fma_f32 v75, -v105, v171, v75
    v_fma_f32 v76, -v105, v172, v76
    v_fma_f32 v77, -v105, v173, v77
    v_fma_f32 v78, -v105, v174, v78
    v_fma_f32 v79, -v105, v175, v79
    v_fma_f32 v64, v64, v104, v176
    v_fma_f32 v65, v65, v104, v177
    v_fma_f32 v66, v66, v104, v178
    v_fma_f32 v67, v67, v104, v179
    v_fma_f32 v68, v68, v104, v180
    v_fma_f32 v69, v69, v104, v181
    v_fma_f32 v70, v70, v104, v182
    v_fma_f32 v71, v71, v104, v183
    v_fma_f32 v72, v72, v104, v184
    v_fma_f32 v73, v73, v104, v185
    v_fma_f32 v74, v74, v104, v186
    v_fma_f32 v75, v75, v104, v187
    v_fma_f32 v76, v76, v104, v188
    v_fma_f32 v77, v77, v104, v189
    v_fma_f32 v78, v78, v104, v190
    v_fma_f32 v79, v79, v104, v191
    v_cvt_pk_bf16_f32 v200, v64, v65
    v_cvt_pk_bf16_f32 v201, v66, v67
    v_cvt_pk_bf16_f32 v202, v68, v69
    v_cvt_pk_bf16_f32 v203, v70, v71
    v_cvt_pk_bf16_f32 v204, v72, v73
    v_cvt_pk_bf16_f32 v205, v74, v75
    v_cvt_pk_bf16_f32 v206, v76, v77
    v_cvt_pk_bf16_f32 v207, v78, v79
    v_pk_max_i16 v200, v200, 0
    v_pk_max_i16 v201, v201, 0
    v_pk_max_i16 v202, v202, 0
    v_pk_max_i16 v203, v203, 0
    v_pk_max_i16 v204, v204, 0
    v_pk_max_i16 v205, v205, 0
    v_pk_max_i16 v206, v206, 0
    v_pk_max_i16 v207, v207, 0
    s_lshr_b32 s15, s3, 2
    s_xor_b32 s15, s15, 0
    s_lshl_b32 s41, s11, 1
    s_add_u32 s15, s15, s41
    s_mul_i32 s15, s15, 114688
    s_lshl_b32 s41, s13, 11
    s_add_u32 s15, s15, s41
    buffer_store_dwordx4 v[200:203], v4, s[28:31], s15 offen sc1
    buffer_store_dwordx4 v[204:207], v4, s[28:31], s15 offen offset:1024 sc1
    v_fma_f32 v80, -v107, v160, v80
    v_fma_f32 v81, -v107, v161, v81
    v_fma_f32 v82, -v107, v162, v82
    v_fma_f32 v83, -v107, v163, v83
    v_fma_f32 v84, -v107, v164, v84
    v_fma_f32 v85, -v107, v165, v85
    v_fma_f32 v86, -v107, v166, v86
    v_fma_f32 v87, -v107, v167, v87
    v_fma_f32 v88, -v107, v168, v88
    v_fma_f32 v89, -v107, v169, v89
    v_fma_f32 v90, -v107, v170, v90
    v_fma_f32 v91, -v107, v171, v91
    v_fma_f32 v92, -v107, v172, v92
    v_fma_f32 v93, -v107, v173, v93
    v_fma_f32 v94, -v107, v174, v94
    v_fma_f32 v95, -v107, v175, v95
    v_fma_f32 v80, v80, v106, v176
    v_fma_f32 v81, v81, v106, v177
    v_fma_f32 v82, v82, v106, v178
    v_fma_f32 v83, v83, v106, v179
    v_fma_f32 v84, v84, v106, v180
    v_fma_f32 v85, v85, v106, v181
    v_fma_f32 v86, v86, v106, v182
    v_fma_f32 v87, v87, v106, v183
    v_fma_f32 v88, v88, v106, v184
    v_fma_f32 v89, v89, v106, v185
    v_fma_f32 v90, v90, v106, v186
    v_fma_f32 v91, v91, v106, v187
    v_fma_f32 v92, v92, v106, v188
    v_fma_f32 v93, v93, v106, v189
    v_fma_f32 v94, v94, v106, v190
    v_fma_f32 v95, v95, v106, v191
    v_cvt_pk_bf16_f32 v208, v80, v81
    v_cvt_pk_bf16_f32 v209, v82, v83
    v_cvt_pk_bf16_f32 v210, v84, v85
    v_cvt_pk_bf16_f32 v211, v86, v87
    v_cvt_pk_bf16_f32 v212, v88, v89
    v_cvt_pk_bf16_f32 v213, v90, v91
    v_cvt_pk_bf16_f32 v214, v92, v93
    v_cvt_pk_bf16_f32 v215, v94, v95
    v_pk_max_i16 v208, v208, 0
    v_pk_max_i16 v209, v209, 0
    v_pk_max_i16 v210, v210, 0
    v_pk_max_i16 v211, v211, 0
    v_pk_max_i16 v212, v212, 0
    v_pk_max_i16 v213, v213, 0
    v_pk_max_i16 v214, v214, 0
    v_pk_max_i16 v215, v215, 0
    s_lshr_b32 s15, s3, 2
    s_xor_b32 s15, s15, 1
    s_lshl_b32 s41, s11, 1
    s_add_u32 s15, s15, s41
    s_mul_i32 s15, s15, 114688
    s_lshl_b32 s41, s13, 11
    s_add_u32 s15, s15, s41
    buffer_store_dwordx4 v[208:211], v4, s[28:31], s15 offen sc1
    buffer_store_dwordx4 v[212:215], v4, s[28:31], s15 offen offset:1024 sc1
    s_setprio 0
    s_branch PC_END
PC_HELP:
    s_sub_u32 s11, s2, 224
    v_lshrrev_b32 v2, 3, v0
    v_and_b32 v3, 7, v0
    v_bfe_u32 v4, v0, 4, 1
    v_lshlrev_b32 v4, 2, v4
    v_xor_b32 v3, v3, v4
    v_lshlrev_b32 v3, 4, v3
    v_lshl_add_u32 v3, v2, 12, v3
    s_lshl_b32 s14, s11, 7
    v_add_u32 v3, s14, v3
    s_lshl_b32 s36, s3, 15
    s_lshl_b32 s37, s3, 10
    s_waitcnt lgkmcnt(0)
    s_cmp_lg_u32 s3, 7
    s_cbranch_scc1 SYN7
    s_mov_b32 s69, 200000
    v_lshlrev_b32 v252, 8, v0
    s_mov_b64 exec, 0xff
    buffer_load_dword v253, v252, s[64:67], 0 offen offset:2176 sc1
POL7:
    s_sleep 1
    buffer_load_dword v254, v252, s[64:67], 0 offen offset:2176 sc1
    s_waitcnt vmcnt(1)
    v_cmp_eq_u32 vcc, 0, v253
    s_cmp_eq_u64 vcc, 0
    s_cbranch_scc1 GOT7
    s_sleep 1
    buffer_load_dword v253, v252, s[64:67], 0 offen offset:2176 sc1
    s_waitcnt vmcnt(1)
    v_cmp_eq_u32 vcc, 0, v254
    s_cmp_eq_u64 vcc, 0
    s_cbranch_scc1 GOT7
    s_sub_u32 s69, s69, 1
    s_cbranch_scc0 POL7
GOT7:
    s_mov_b64 exec, -1
SYN7:
    s_barrier
    s_add_u32 s16, s4, 0x500000
    s_addc_u32 s17, s5, 0
    s_mov_b32 s18, 0x200000
    s_mov_b32 s19, 0x20000
    s_mov_b32 m0, s37
    s_add_u32 s37, s37, 8192
    buffer_load_dwordx4 v3, s[16:19], s36 offen sc1 lds
    s_add_u32 s36, s36, 0x40000
    s_mov_b32 m0, s37
    s_add_u32 s37, s37, 8192
    buffer_load_dwordx4 v3, s[16:19], s36 offen sc1 lds
    s_add_u32 s36, s36, 0x40000
    s_mov_b32 m0, s37
    s_add_u32 s37, s37, 8192
    buffer_load_dwordx4 v3, s[16:19], s36 offen sc1 lds
    s_add_u32 s36, s36, 0x40000
    s_mov_b32 m0, s37
    s_add_u32 s37, s37, 8192
    buffer_load_dwordx4 v3, s[16:19], s36 offen sc1 lds
    s_add_u32 s36, s36, 0x40000
    s_mov_b32 m0, s37
    s_add_u32 s37, s37, 8192
    buffer_load_dwordx4 v3, s[16:19], s36 offen sc1 lds
    s_add_u32 s36, s36, 0x40000
    s_mov_b32 m0, s37
    s_add_u32 s37, s37, 8192
    buffer_load_dwordx4 v3, s[16:19], s36 offen sc1 lds
    s_add_u32 s36, s36, 0x40000
    s_mov_b32 m0, s37
    s_add_u32 s37, s37, 8192
    buffer_load_dwordx4 v3, s[16:19], s36 offen sc1 lds
    s_add_u32 s36, s36, 0x40000
    s_mov_b32 m0, s37
    s_add_u32 s37, s37, 8192
    buffer_load_dwordx4 v3, s[16:19], s36 offen sc1 lds
    s_add_u32 s36, s36, 0x40000
    s_add_u32 s32, s4, 0x700000
    s_addc_u32 s33, s5, 0
    s_mov_b32 s34, 0x200000
    s_mov_b32 s35, 0x20000
    s_add_u32 s20, s4, 0x420000
    s_addc_u32 s21, s5, 0
    s_mov_b32 s22, 0x4000
    s_mov_b32 s23, 0x20000
    s_add_u32 s48, s4, 0x43a000
    s_addc_u32 s49, s5, 0
    s_mov_b32 s50, 0x1000
    s_mov_b32 s51, 0x20000
    v_bfe_u32 v5, v0, 2, 2
    v_and_b32 v6, 3, v0
    v_bfe_u32 v7, v0, 4, 1
    v_lshrrev_b32 v12, 5, v0
    v_lshlrev_b32 v13, 3, v12
    v_add_u32 v13, v13, v5
    v_lshlrev_b32 v13, 7, v13
    v_lshl_add_u32 v13, v7, 5, v13
    v_lshl_add_u32 v13, v6, 3, v13
    v_lshrrev_b32 v14, 1, v5
    s_lshr_b32 s39, s3, 2
    v_xor_b32 v14, s39, v14
    v_lshl_add_u32 v8, v14, 6, v13
    v_xor_b32 v9, 64, v8
    s_lshl_b32 s15, s3, 13
    v_add_u32 v46, s15, v8
    v_add_u32 v47, s15, v9
    v_and_b32 v54, 31, v0
    v_lshlrev_b32 v54, 3, v54
    v_lshl_add_u32 v54, v12, 9, v54
    s_lshl_b32 s15, s11, 1
    s_lshr_b32 s41, s3, 2
    s_add_u32 s15, s15, s41
    s_lshl_b32 s15, s15, 15
    s_lshl_b32 s41, s3, 12
    s_add_u32 s15, s15, s41
    s_xor_b32 s56, s15, 0x8000
    s_mov_b32 s43, 0x3f803f80
    v_mov_b32 v60, 0
    v_mov_b32 v61, 0
    v_mov_b32 v62, 0
    v_mov_b32 v63, 0
    v_mov_b32 v64, 0
    v_mov_b32 v65, 0
    v_mov_b32 v66, 0
    v_mov_b32 v67, 0
    s_waitcnt vmcnt(0)
    s_barrier
    ds_read_b64_tr_b16 v[128:129], v46 offset:0
    ds_read_b64_tr_b16 v[130:131], v46 offset:512
    ds_read_b64_tr_b16 v[132:133], v46 offset:2048
    ds_read_b64_tr_b16 v[134:135], v46 offset:2560
    ds_read_b64_tr_b16 v[136:137], v46 offset:4096
    ds_read_b64_tr_b16 v[138:139], v46 offset:4608
    ds_read_b64_tr_b16 v[140:141], v46 offset:6144
    ds_read_b64_tr_b16 v[142:143], v46 offset:6656
    s_waitcnt lgkmcnt(0)
    ds_read_b64_tr_b16 v[144:145], v47 offset:0
    ds_read_b64_tr_b16 v[146:147], v47 offset:512
    ds_read_b64_tr_b16 v[148:149], v47 offset:2048
    ds_read_b64_tr_b16 v[150:151], v47 offset:2560
    ds_read_b64_tr_b16 v[152:153], v47 offset:4096
    ds_read_b64_tr_b16 v[154:155], v47 offset:4608
    ds_read_b64_tr_b16 v[156:157], v47 offset:6144
    ds_read_b64_tr_b16 v[158:159], v47 offset:6656
    s_waitcnt lgkmcnt(0)
    v_dot2_f32_bf16 v60, v128, s43, v60
    v_dot2_f32_bf16 v62, v128, v128, v62
    v_dot2_f32_bf16 v61, v129, s43, v61
    v_dot2_f32_bf16 v63, v129, v129, v63
    v_dot2_f32_bf16 v60, v130, s43, v60
    v_dot2_f32_bf16 v62, v130, v130, v62
    v_dot2_f32_bf16 v61, v131, s43, v61
    v_dot2_f32_bf16 v63, v131, v131, v63
    v_dot2_f32_bf16 v60, v132, s43, v60
    v_dot2_f32_bf16 v62, v132, v132, v62
    v_dot2_f32_bf16 v61, v133, s43, v61
    v_dot2_f32_bf16 v63, v133, v133, v63
    v_dot2_f32_bf16 v60, v134, s43, v60
    v_dot2_f32_bf16 v62, v134, v134, v62
    v_dot2_f32_bf16 v61, v135, s43, v61
    v_dot2_f32_bf16 v63, v135, v135, v63
    v_dot2_f32_bf16 v60, v136, s43, v60
    v_dot2_f32_bf16 v62, v136, v136, v62
    v_dot2_f32_bf16 v61, v137, s43, v61
    v_dot2_f32_bf16 v63, v137, v137, v63
    v_dot2_f32_bf16 v60, v138, s43, v60
    v_dot2_f32_bf16 v62, v138, v138, v62
    v_dot2_f32_bf16 v61, v139, s43, v61
    v_dot2_f32_bf16 v63, v139, v139, v63
    v_dot2_f32_bf16 v60, v140, s43, v60
    v_dot2_f32_bf16 v62, v140, v140, v62
    v_dot2_f32_bf16 v61, v141, s43, v61
    v_dot2_f32_bf16 v63, v141, v141, v63
    v_dot2_f32_bf16 v60, v142, s43, v60
    v_dot2_f32_bf16 v62, v142, v142, v62
    v_dot2_f32_bf16 v61, v143, s43, v61
    v_dot2_f32_bf16 v63, v143, v143, v63
    v_dot2_f32_bf16 v64, v144, s43, v64
    v_dot2_f32_bf16 v66, v144, v144, v66
    v_dot2_f32_bf16 v65, v145, s43, v65
    v_dot2_f32_bf16 v67, v145, v145, v67
    v_dot2_f32_bf16 v64, v146, s43, v64
    v_dot2_f32_bf16 v66, v146, v146, v66
    v_dot2_f32_bf16 v65, v147, s43, v65
    v_dot2_f32_bf16 v67, v147, v147, v67
    v_dot2_f32_bf16 v64, v148, s43, v64
    v_dot2_f32_bf16 v66, v148, v148, v66
    v_dot2_f32_bf16 v65, v149, s43, v65
    v_dot2_f32_bf16 v67, v149, v149, v67
    v_dot2_f32_bf16 v64, v150, s43, v64
    v_dot2_f32_bf16 v66, v150, v150, v66
    v_dot2_f32_bf16 v65, v151, s43, v65
    v_dot2_f32_bf16 v67, v151, v151, v67
    v_dot2_f32_bf16 v64, v152, s43, v64
    v_dot2_f32_bf16 v66, v152, v152, v66
    v_dot2_f32_bf16 v65, v153, s43, v65
    v_dot2_f32_bf16 v67, v153, v153, v67
    v_dot2_f32_bf16 v64, v154, s43, v64
    v_dot2_f32_bf16 v66, v154, v154, v66
    v_dot2_f32_bf16 v65, v155, s43, v65
    v_dot2_f32_bf16 v67, v155, v155, v67
    v_dot2_f32_bf16 v64, v156, s43, v64
    v_dot2_f32_bf16 v66, v156, v156, v66
    v_dot2_f32_bf16 v65, v157, s43, v65
    v_dot2_f32_bf16 v67, v157, v157, v67
    v_dot2_f32_bf16 v64, v158, s43, v64
    v_dot2_f32_bf16 v66, v158, v158, v66
    v_dot2_f32_bf16 v65, v159, s43, v65
    v_dot2_f32_bf16 v67, v159, v159, v67
    s_nop 2
    v_add_f32 v70, v60, v61
    v_add_f32 v71, v62, v63
    v_add_f32 v72, v64, v65
    v_add_f32 v73, v66, v67
    v_lshlrev_b32 v15, 3, v0
    s_lshr_b32 s41, s3, 2
    s_lshl_b32 s41, s41, 12
    s_lshl_b32 s42, s3, 9
    s_add_u32 s41, s41, s42
    s_add_u32 s41, s41, 65536
    v_add_u32 v48, s41, v15
    v_xor_b32 v49, 0x1000, v48
    ds_write_b64 v48, v[70:71]
    ds_write_b64 v49, v[72:73]
    s_waitcnt lgkmcnt(0)
    s_barrier
    s_cmp_eq_u32 s3, 0
    s_cbranch_scc1 PC_H0
PC_HX:
    buffer_store_dwordx2 v[128:129], v54, s[32:35], s15 offen offset:0 sc1
    buffer_store_dwordx2 v[130:131], v54, s[32:35], s15 offen offset:256 sc1
    buffer_store_dwordx2 v[132:133], v54, s[32:35], s15 offen offset:1024 sc1
    buffer_store_dwordx2 v[134:135], v54, s[32:35], s15 offen offset:1280 sc1
    buffer_store_dwordx2 v[136:137], v54, s[32:35], s15 offen offset:2048 sc1
    buffer_store_dwordx2 v[138:139], v54, s[32:35], s15 offen offset:2304 sc1
    buffer_store_dwordx2 v[140:141], v54, s[32:35], s15 offen offset:3072 sc1
    buffer_store_dwordx2 v[142:143], v54, s[32:35], s15 offen offset:3328 sc1
    buffer_store_dwordx2 v[144:145], v54, s[32:35], s56 offen offset:0 sc1
    buffer_store_dwordx2 v[146:147], v54, s[32:35], s56 offen offset:256 sc1
    buffer_store_dwordx2 v[148:149], v54, s[32:35], s56 offen offset:1024 sc1
    buffer_store_dwordx2 v[150:151], v54, s[32:35], s56 offen offset:1280 sc1
    buffer_store_dwordx2 v[152:153], v54, s[32:35], s56 offen offset:2048 sc1
    buffer_store_dwordx2 v[154:155], v54, s[32:35], s56 offen offset:2304 sc1
    buffer_store_dwordx2 v[156:157], v54, s[32:35], s56 offen offset:3072 sc1
    buffer_store_dwordx2 v[158:159], v54, s[32:35], s56 offen offset:3328 sc1
    s_branch PC_END
PC_H0:
    v_lshrrev_b32 v13, 5, v0
    v_and_b32 v14, 31, v0
    v_lshlrev_b32 v13, 12, v13
    v_lshl_add_u32 v13, v14, 3, v13
    v_add_u32 v13, 65536, v13
    ds_read_b64 v[16:17], v13 offset:0
    ds_read_b64 v[18:19], v13 offset:256
    ds_read_b64 v[20:21], v13 offset:512
    ds_read_b64 v[22:23], v13 offset:768
    ds_read_b64 v[24:25], v13 offset:1024
    ds_read_b64 v[26:27], v13 offset:1280
    ds_read_b64 v[28:29], v13 offset:1536
    ds_read_b64 v[30:31], v13 offset:1792
    ds_read_b64 v[32:33], v13 offset:2048
    ds_read_b64 v[34:35], v13 offset:2304
    ds_read_b64 v[36:37], v13 offset:2560
    ds_read_b64 v[38:39], v13 offset:2816
    ds_read_b64 v[40:41], v13 offset:3072
    ds_read_b64 v[42:43], v13 offset:3328
    ds_read_b64 v[44:45], v13 offset:3584
    s_waitcnt lgkmcnt(0)
    ds_read_b64 v[46:47], v13 offset:3840
    s_waitcnt lgkmcnt(0)
    v_add_f32 v16, v16, v32
    v_add_f32 v17, v17, v33
    v_add_f32 v18, v18, v34
    v_add_f32 v19, v19, v35
    v_add_f32 v20, v20, v36
    v_add_f32 v21, v21, v37
    v_add_f32 v22, v22, v38
    v_add_f32 v23, v23, v39
    v_add_f32 v24, v24, v40
    v_add_f32 v25, v25, v41
    v_add_f32 v26, v26, v42
    v_add_f32 v27, v27, v43
    v_add_f32 v28, v28, v44
    v_add_f32 v29, v29, v45
    v_add_f32 v30, v30, v46
    v_add_f32 v31, v31, v47
    v_add_f32 v16, v16, v24
    v_add_f32 v17, v17, v25
    v_add_f32 v18, v18, v26
    v_add_f32 v19, v19, v27
    v_add_f32 v20, v20, v28
    v_add_f32 v21, v21, v29
    v_add_f32 v22, v22, v30
    v_add_f32 v23, v23, v31
    v_add_f32 v16, v16, v20
    v_add_f32 v17, v17, v21
    v_add_f32 v18, v18, v22
    v_add_f32 v19, v19, v23
    v_add_f32 v16, v16, v18
    v_add_f32 v17, v17, v19
    v_mul_f32 v19, 0x3b000000, v16
    v_mul_f32 v20, 0x3b000000, v17
    v_fma_f32 v20, -v19, v19, v20
    v_max_f32 v20, 0, v20
    v_cvt_pk_bf16_f32 v20, v20, v20
    v_and_b32 v20, 0xffff0000, v20
    v_add_f32 v20, 0x3727c5ac, v20
    v_cvt_pk_bf16_f32 v20, v20, v20
    v_and_b32 v20, 0xffff0000, v20
    v_sqrt_f32 v20, v20
    s_nop 0
    v_cvt_pk_bf16_f32 v20, v20, v20
    v_and_b32 v20, 0xffff0000, v20
    v_rcp_f32 v18, v20
    v_cvt_pk_bf16_f32 v19, v19, v19
    v_and_b32 v19, 0xffff0000, v19
    v_or_b32 v18, 1, v18
    s_lshl_b32 s16, s11, 9
    v_lshlrev_b32 v13, 3, v0
    buffer_store_dwordx2 v[18:19], v13, s[20:23], s16 offen sc1
    s_branch PC_HX
PC_END:
    s_waitcnt vmcnt(0) lgkmcnt(0)
    s_barrier
    s_cmp_lg_u32 s3, 7
    s_cbranch_scc1 ARS8
    v_mov_b32 v1, 1
    s_mov_b64 exec, 1
    s_and_b32 s68, s2, 31
    s_lshl_b32 s68, s68, 7
    s_add_u32 s68, s68, 0x1000
    buffer_atomic_add v1, off, s[64:67], s68 sc1
    s_mov_b64 exec, -1
ARS8:
    s_cmp_ge_u32 s3, 4
    s_cbranch_scc1 PD_IDLE
    s_load_dwordx2 s[6:7], s[0:1], 88
    s_and_b32 s11, s2, 31
    s_lshr_b32 s12, s2, 5
    v_lshlrev_b32 v2, 4, v0
    s_mul_i32 s13, s12, 229376
    v_add_u32 v3, s13, v2
    v_add_u32 v4, 114688, v3
    s_mul_i32 s13, s11, 229376
    v_add_u32 v5, s13, v2
    v_add_u32 v6, 114688, v5
    s_mul_i32 s14, s3, 28672
    s_waitcnt lgkmcnt(0)
    s_add_u32 s16, s4, 0xb00000
    s_addc_u32 s17, s5, 0
    s_mov_b32 s18, 0x1c0000
    s_mov_b32 s19, 0x20000
    s_add_u32 s20, s4, 0xd00000
    s_addc_u32 s21, s5, 0
    s_mov_b32 s22, 0x700000
    s_mov_b32 s23, 0x20000
    s_mov_b32 s41, s14
    buffer_load_dwordx4 v[80:83], v3, s[16:19], s14 offen sc1
    buffer_load_dwordx4 v[84:87], v4, s[16:19], s14 offen sc1
    s_add_u32 s14, s14, 1024
    buffer_load_dwordx4 v[96:99], v3, s[16:19], s14 offen sc1
    buffer_load_dwordx4 v[100:103], v4, s[16:19], s14 offen sc1
    s_add_u32 s14, s14, 1024
    buffer_load_dwordx4 v[112:115], v3, s[16:19], s14 offen sc1
    buffer_load_dwordx4 v[116:119], v4, s[16:19], s14 offen sc1
    s_add_u32 s14, s14, 1024
    buffer_load_dwordx4 v[128:131], v3, s[16:19], s14 offen sc1
    buffer_load_dwordx4 v[132:135], v4, s[16:19], s14 offen sc1
    s_add_u32 s14, s14, 1024
    buffer_load_dwordx4 v[144:147], v3, s[16:19], s14 offen sc1
    buffer_load_dwordx4 v[148:151], v4, s[16:19], s14 offen sc1
    s_add_u32 s14, s14, 1024
    buffer_load_dwordx4 v[160:163], v3, s[16:19], s14 offen sc1
    buffer_load_dwordx4 v[164:167], v4, s[16:19], s14 offen sc1
    s_add_u32 s14, s14, 1024
    buffer_load_dwordx4 v[176:179], v3, s[16:19], s14 offen sc1
    buffer_load_dwordx4 v[180:183], v4, s[16:19], s14 offen sc1
    s_add_u32 s14, s14, 1024
    buffer_load_dwordx4 v[192:195], v3, s[16:19], s14 offen sc1
    buffer_load_dwordx4 v[196:199], v4, s[16:19], s14 offen sc1
    s_add_u32 s14, s14, 1024
    s_add_u32 s24, s4, 0x700000
    s_addc_u32 s25, s5, 0
    s_mov_b32 s26, 0x200000
    s_mov_b32 s27, 0x20000
    s_mov_b32 s28, s6
    s_mov_b32 s29, s7
    s_mov_b32 s30, 0x200000
    s_mov_b32 s31, 0x20000
    s_add_u32 s32, s4, 0x404000
    s_addc_u32 s33, s5, 0
    s_mov_b32 s34, 0x3000
    s_mov_b32 s35, 0x20000
    s_lshr_b32 s15, s3, 1
    s_and_b32 s36, s3, 1
    v_and_b32 v7, 31, v0
    v_lshrrev_b32 v8, 5, v0
    s_lshl_b32 s37, s11, 1
    s_add_u32 s37, s37, s36
    s_lshl_b32 s37, s37, 15
    s_lshl_b32 s38, s12, 1
    s_add_u32 s38, s38, s15
    s_lshl_b32 s39, s38, 11
    s_add_u32 s37, s37, s39
    v_lshlrev_b32 v10, 3, v0
    v_lshlrev_b32 v9, 4, v8
    s_lshl_b32 s38, s38, 7
    s_add_u32 s38, s38, 10240
    buffer_load_dwordx4 v[216:219], v9, s[32:35], s38 offen offset:0 sc1
    buffer_load_dwordx4 v[220:223], v9, s[32:35], s38 offen offset:32 sc1
    buffer_load_dwordx4 v[224:227], v9, s[32:35], s38 offen offset:64 sc1
    buffer_load_dwordx4 v[228:231], v9, s[32:35], s38 offen offset:96 sc1
    s_mul_i32 s42, s3, 28672
    s_add_u32 s42, s42, 18432
    buffer_load_dwordx4 v[232:235], v3, s[16:19], s42 offen sc1
    buffer_load_dwordx4 v[236:239], v4, s[16:19], s42 offen sc1
    s_add_u32 s42, s42, 1024
    buffer_load_dwordx4 v[240:243], v3, s[16:19], s42 offen sc1
    buffer_load_dwordx4 v[244:247], v4, s[16:19], s42 offen sc1
    s_add_u32 s42, s42, 1024
    buffer_load_dwordx4 v[248:251], v3, s[16:19], s42 offen sc1
    buffer_load_dwordx4 v[252:255], v4, s[16:19], s42 offen sc1
    s_add_u32 s42, s42, 1024
    v_mov_b32 v16, 0
    v_mov_b32 v17, 0
    v_mov_b32 v18, 0
    v_mov_b32 v19, 0
    v_mov_b32 v20, 0
    v_mov_b32 v21, 0
    v_mov_b32 v22, 0
    v_mov_b32 v23, 0
    v_mov_b32 v24, 0
    v_mov_b32 v25, 0
    v_mov_b32 v26, 0
    v_mov_b32 v27, 0
    v_mov_b32 v28, 0
    v_mov_b32 v29, 0
    v_mov_b32 v30, 0
    v_mov_b32 v31, 0
    v_mov_b32 v32, 0
    v_mov_b32 v33, 0
    v_mov_b32 v34, 0
    v_mov_b32 v35, 0
    v_mov_b32 v36, 0
    v_mov_b32 v37, 0
    v_mov_b32 v38, 0
    v_mov_b32 v39, 0
    v_mov_b32 v40, 0
    v_mov_b32 v41, 0
    v_mov_b32 v42, 0
    v_mov_b32 v43, 0
    v_mov_b32 v44, 0
    v_mov_b32 v45, 0
    v_mov_b32 v46, 0
    v_mov_b32 v47, 0
    v_mov_b32 v48, 0
    v_mov_b32 v49, 0
    v_mov_b32 v50, 0
    v_mov_b32 v51, 0
    v_mov_b32 v52, 0
    v_mov_b32 v53, 0
    v_mov_b32 v54, 0
    v_mov_b32 v55, 0
    v_mov_b32 v56, 0
    v_mov_b32 v57, 0
    v_mov_b32 v58, 0
    v_mov_b32 v59, 0
    v_mov_b32 v60, 0
    v_mov_b32 v61, 0
    v_mov_b32 v62, 0
    v_mov_b32 v63, 0
    v_mov_b32 v64, 0
    v_mov_b32 v65, 0
    v_mov_b32 v66, 0
    v_mov_b32 v67, 0
    v_mov_b32 v68, 0
    v_mov_b32 v69, 0
    v_mov_b32 v70, 0
    v_mov_b32 v71, 0
    v_mov_b32 v72, 0
    v_mov_b32 v73, 0
    v_mov_b32 v74, 0
    v_mov_b32 v75, 0
    v_mov_b32 v76, 0
    v_mov_b32 v77, 0
    v_mov_b32 v78, 0
    v_mov_b32 v79, 0
    s_mul_i32 s39, s3, 20480
    s_add_u32 s39, s39, 77824
    v_bfe_u32 v13, v0, 2, 2
    v_lshrrev_b32 v14, 5, v0
    v_lshl_add_u32 v14, v14, 2, v13
    v_lshlrev_b32 v14, 7, v14
    v_bfe_u32 v15, v0, 4, 1
    v_lshl_add_u32 v14, v15, 5, v14
    v_and_b32 v15, 3, v0
    v_lshl_add_u32 v14, v15, 3, v14
    v_lshrrev_b32 v13, 1, v13
    v_lshl_add_u32 v14, v13, 6, v14
    v_add_u32 v12, s39, v14
    v_xor_b32 v13, 64, v12
    s_barrier
    buffer_load_dwordx4 v[88:91], v5, s[20:23], s41 offen sc1
    buffer_load_dwordx4 v[92:95], v6, s[20:23], s41 offen sc1
    s_add_u32 s41, s41, 1024
    buffer_load_dwordx4 v[104:107], v5, s[20:23], s41 offen sc1
    buffer_load_dwordx4 v[108:111], v6, s[20:23], s41 offen sc1
    s_add_u32 s41, s41, 1024
    buffer_load_dwordx2 v[208:209], v10, s[24:27], s37 offen offset:0 sc1
    buffer_load_dwordx2 v[210:211], v10, s[24:27], s37 offen offset:512 sc1
    buffer_load_dwordx2 v[212:213], v10, s[24:27], s37 offen offset:1024 sc1
    buffer_load_dwordx2 v[214:215], v10, s[24:27], s37 offen offset:1536 sc1
    buffer_load_dwordx4 v[120:123], v5, s[20:23], s41 offen sc1
    buffer_load_dwordx4 v[124:127], v6, s[20:23], s41 offen sc1
    s_add_u32 s41, s41, 1024
    buffer_load_dwordx4 v[136:139], v5, s[20:23], s41 offen sc1
    buffer_load_dwordx4 v[140:143], v6, s[20:23], s41 offen sc1
    s_add_u32 s41, s41, 1024
    buffer_load_dwordx4 v[152:155], v5, s[20:23], s41 offen sc1
    buffer_load_dwordx4 v[156:159], v6, s[20:23], s41 offen sc1
    s_add_u32 s41, s41, 1024
    buffer_load_dwordx4 v[168:171], v5, s[20:23], s41 offen sc1
    buffer_load_dwordx4 v[172:175], v6, s[20:23], s41 offen sc1
    s_add_u32 s41, s41, 1024
    buffer_load_dwordx4 v[184:187], v5, s[20:23], s41 offen sc1
    buffer_load_dwordx4 v[188:191], v6, s[20:23], s41 offen sc1
    s_add_u32 s41, s41, 1024
    buffer_load_dwordx4 v[200:203], v5, s[20:23], s41 offen sc1
    buffer_load_dwordx4 v[204:207], v6, s[20:23], s41 offen sc1
    s_add_u32 s41, s41, 1024
    s_waitcnt vmcnt(18)
    v_mfma_f32_32x32x16_bf16 v[16:31], v[80:83], v[88:91], v[16:31]
    v_mfma_f32_32x32x16_bf16 v[32:47], v[80:83], v[92:95], v[32:47]
    v_mfma_f32_32x32x16_bf16 v[48:63], v[84:87], v[88:91], v[48:63]
    v_mfma_f32_32x32x16_bf16 v[64:79], v[84:87], v[92:95], v[64:79]
    ds_read_b64_tr_b16 v[80:81], v12 offset:0
    ds_read_b64_tr_b16 v[82:83], v12 offset:1024
    ds_read_b64_tr_b16 v[84:85], v13 offset:0
    ds_read_b64_tr_b16 v[86:87], v13 offset:1024
    s_add_u32 s14, s14, 1024
    buffer_load_dwordx4 v[88:91], v5, s[20:23], s41 offen sc1
    buffer_load_dwordx4 v[92:95], v6, s[20:23], s41 offen sc1
    s_add_u32 s41, s41, 1024
    s_waitcnt vmcnt(18)
    v_mfma_f32_32x32x16_bf16 v[16:31], v[96:99], v[104:107], v[16:31]
    v_mfma_f32_32x32x16_bf16 v[32:47], v[96:99], v[108:111], v[32:47]
    v_mfma_f32_32x32x16_bf16 v[48:63], v[100:103], v[104:107], v[48:63]
    v_mfma_f32_32x32x16_bf16 v[64:79], v[100:103], v[108:111], v[64:79]
    ds_read_b64_tr_b16 v[96:97], v12 offset:2048
    ds_read_b64_tr_b16 v[98:99], v12 offset:3072
    ds_read_b64_tr_b16 v[100:101], v13 offset:2048
    ds_read_b64_tr_b16 v[102:103], v13 offset:3072
    s_add_u32 s14, s14, 1024
    buffer_load_dwordx4 v[104:107], v5, s[20:23], s41 offen sc1
    buffer_load_dwordx4 v[108:111], v6, s[20:23], s41 offen sc1
    s_add_u32 s41, s41, 1024
    s_waitcnt vmcnt(14)
    v_mfma_f32_32x32x16_bf16 v[16:31], v[112:115], v[120:123], v[16:31]
    v_mfma_f32_32x32x16_bf16 v[32:47], v[112:115], v[124:127], v[32:47]
    v_mfma_f32_32x32x16_bf16 v[48:63], v[116:119], v[120:123], v[48:63]
    v_mfma_f32_32x32x16_bf16 v[64:79], v[116:119], v[124:127], v[64:79]
    ds_read_b64_tr_b16 v[112:113], v12 offset:4096
    ds_read_b64_tr_b16 v[114:115], v12 offset:5120
    ds_read_b64_tr_b16 v[116:117], v13 offset:4096
    ds_read_b64_tr_b16 v[118:119], v13 offset:5120
    s_add_u32 s14, s14, 1024
    buffer_load_dwordx4 v[120:123], v5, s[20:23], s41 offen sc1
    buffer_load_dwordx4 v[124:127], v6, s[20:23], s41 offen sc1
    s_add_u32 s41, s41, 1024
    s_waitcnt vmcnt(14)
    v_mfma_f32_32x32x16_bf16 v[16:31], v[128:131], v[136:139], v[16:31]
    v_mfma_f32_32x32x16_bf16 v[32:47], v[128:131], v[140:143], v[32:47]
    v_mfma_f32_32x32x16_bf16 v[48:63], v[132:135], v[136:139], v[48:63]
    v_mfma_f32_32x32x16_bf16 v[64:79], v[132:135], v[140:143], v[64:79]
    ds_read_b64_tr_b16 v[128:129], v12 offset:6144
    ds_read_b64_tr_b16 v[130:131], v12 offset:7168
    ds_read_b64_tr_b16 v[132:133], v13 offset:6144
    ds_read_b64_tr_b16 v[134:135], v13 offset:7168
    s_add_u32 s14, s14, 1024
    buffer_load_dwordx4 v[136:139], v5, s[20:23], s41 offen sc1
    buffer_load_dwordx4 v[140:143], v6, s[20:23], s41 offen sc1
    s_add_u32 s41, s41, 1024
    s_waitcnt vmcnt(14)
    v_mfma_f32_32x32x16_bf16 v[16:31], v[144:147], v[152:155], v[16:31]
    v_mfma_f32_32x32x16_bf16 v[32:47], v[144:147], v[156:159], v[32:47]
    v_mfma_f32_32x32x16_bf16 v[48:63], v[148:151], v[152:155], v[48:63]
    v_mfma_f32_32x32x16_bf16 v[64:79], v[148:151], v[156:159], v[64:79]
    ds_read_b64_tr_b16 v[144:145], v12 offset:8192
    ds_read_b64_tr_b16 v[146:147], v12 offset:9216
    ds_read_b64_tr_b16 v[148:149], v13 offset:8192
    ds_read_b64_tr_b16 v[150:151], v13 offset:9216
    s_add_u32 s14, s14, 1024
    buffer_load_dwordx4 v[152:155], v5, s[20:23], s41 offen sc1
    buffer_load_dwordx4 v[156:159], v6, s[20:23], s41 offen sc1
    s_add_u32 s41, s41, 1024
    s_waitcnt vmcnt(14)
    v_mfma_f32_32x32x16_bf16 v[16:31], v[160:163], v[168:171], v[16:31]
    v_mfma_f32_32x32x16_bf16 v[32:47], v[160:163], v[172:175], v[32:47]
    v_mfma_f32_32x32x16_bf16 v[48:63], v[164:167], v[168:171], v[48:63]
    v_mfma_f32_32x32x16_bf16 v[64:79], v[164:167], v[172:175], v[64:79]
    ds_read_b64_tr_b16 v[160:161], v12 offset:10240
    ds_read_b64_tr_b16 v[162:163], v12 offset:11264
    ds_read_b64_tr_b16 v[164:165], v13 offset:10240
    ds_read_b64_tr_b16 v[166:167], v13 offset:11264
    s_add_u32 s14, s14, 1024
    buffer_load_dwordx4 v[168:171], v5, s[20:23], s41 offen sc1
    buffer_load_dwordx4 v[172:175], v6, s[20:23], s41 offen sc1
    s_add_u32 s41, s41, 1024
    s_waitcnt vmcnt(14)
    v_mfma_f32_32x32x16_bf16 v[16:31], v[176:179], v[184:187], v[16:31]
    v_mfma_f32_32x32x16_bf16 v[32:47], v[176:179], v[188:191], v[32:47]
    v_mfma_f32_32x32x16_bf16 v[48:63], v[180:183], v[184:187], v[48:63]
    v_mfma_f32_32x32x16_bf16 v[64:79], v[180:183], v[188:191], v[64:79]
    ds_read_b64_tr_b16 v[176:177], v12 offset:12288
    ds_read_b64_tr_b16 v[178:179], v12 offset:13312
    ds_read_b64_tr_b16 v[180:181], v13 offset:12288
    ds_read_b64_tr_b16 v[182:183], v13 offset:13312
    s_add_u32 s14, s14, 1024
    buffer_load_dwordx4 v[184:187], v5, s[20:23], s41 offen sc1
    buffer_load_dwordx4 v[188:191], v6, s[20:23], s41 offen sc1
    s_add_u32 s41, s41, 1024
    s_waitcnt vmcnt(14)
    v_mfma_f32_32x32x16_bf16 v[16:31], v[192:195], v[200:203], v[16:31]
    v_mfma_f32_32x32x16_bf16 v[32:47], v[192:195], v[204:207], v[32:47]
    v_mfma_f32_32x32x16_bf16 v[48:63], v[196:199], v[200:203], v[48:63]
    v_mfma_f32_32x32x16_bf16 v[64:79], v[196:199], v[204:207], v[64:79]
    ds_read_b64_tr_b16 v[192:193], v12 offset:14336
    ds_read_b64_tr_b16 v[194:195], v12 offset:15360
    ds_read_b64_tr_b16 v[196:197], v13 offset:14336
    ds_read_b64_tr_b16 v[198:199], v13 offset:15360
    s_add_u32 s14, s14, 1024
    buffer_load_dwordx4 v[200:203], v5, s[20:23], s41 offen sc1
    buffer_load_dwordx4 v[204:207], v6, s[20:23], s41 offen sc1
    s_add_u32 s41, s41, 1024
    s_waitcnt vmcnt(14) lgkmcnt(12)
    v_mfma_f32_32x32x16_bf16 v[16:31], v[80:83], v[88:91], v[16:31]
    v_mfma_f32_32x32x16_bf16 v[32:47], v[80:83], v[92:95], v[32:47]
    v_mfma_f32_32x32x16_bf16 v[48:63], v[84:87], v[88:91], v[48:63]
    v_mfma_f32_32x32x16_bf16 v[64:79], v[84:87], v[92:95], v[64:79]
    ds_read_b64_tr_b16 v[80:81], v12 offset:16384
    ds_read_b64_tr_b16 v[82:83], v12 offset:17408
    ds_read_b64_tr_b16 v[84:85], v13 offset:16384
    ds_read_b64_tr_b16 v[86:87], v13 offset:17408
    s_add_u32 s14, s14, 1024
    buffer_load_dwordx4 v[88:91], v5, s[20:23], s41 offen sc1
    buffer_load_dwordx4 v[92:95], v6, s[20:23], s41 offen sc1
    s_add_u32 s41, s41, 1024
    s_waitcnt vmcnt(14) lgkmcnt(12)
    v_mfma_f32_32x32x16_bf16 v[16:31], v[96:99], v[104:107], v[16:31]
    v_mfma_f32_32x32x16_bf16 v[32:47], v[96:99], v[108:111], v[32:47]
    v_mfma_f32_32x32x16_bf16 v[48:63], v[100:103], v[104:107], v[48:63]
    v_mfma_f32_32x32x16_bf16 v[64:79], v[100:103], v[108:111], v[64:79]
    ds_read_b64_tr_b16 v[96:97], v12 offset:18432
    ds_read_b64_tr_b16 v[98:99], v12 offset:19456
    ds_read_b64_tr_b16 v[100:101], v13 offset:18432
    ds_read_b64_tr_b16 v[102:103], v13 offset:19456
    s_add_u32 s14, s14, 1024
    buffer_load_dwordx4 v[104:107], v5, s[20:23], s41 offen sc1
    buffer_load_dwordx4 v[108:111], v6, s[20:23], s41 offen sc1
    s_add_u32 s41, s41, 1024
    s_waitcnt vmcnt(14) lgkmcnt(12)
    v_mfma_f32_32x32x16_bf16 v[16:31], v[112:115], v[120:123], v[16:31]
    v_mfma_f32_32x32x16_bf16 v[32:47], v[112:115], v[124:127], v[32:47]
    v_mfma_f32_32x32x16_bf16 v[48:63], v[116:119], v[120:123], v[48:63]
    v_mfma_f32_32x32x16_bf16 v[64:79], v[116:119], v[124:127], v[64:79]
    s_add_u32 s14, s14, 1024
    buffer_load_dwordx4 v[120:123], v5, s[20:23], s41 offen sc1
    buffer_load_dwordx4 v[124:127], v6, s[20:23], s41 offen sc1
    s_add_u32 s41, s41, 1024
    s_waitcnt vmcnt(14) lgkmcnt(12)
    v_mfma_f32_32x32x16_bf16 v[16:31], v[128:131], v[136:139], v[16:31]
    v_mfma_f32_32x32x16_bf16 v[32:47], v[128:131], v[140:143], v[32:47]
    v_mfma_f32_32x32x16_bf16 v[48:63], v[132:135], v[136:139], v[48:63]
    v_mfma_f32_32x32x16_bf16 v[64:79], v[132:135], v[140:143], v[64:79]
    s_add_u32 s14, s14, 1024
    buffer_load_dwordx4 v[136:139], v5, s[20:23], s41 offen sc1
    buffer_load_dwordx4 v[140:143], v6, s[20:23], s41 offen sc1
    s_add_u32 s41, s41, 1024
    s_waitcnt vmcnt(14) lgkmcnt(12)
    v_mfma_f32_32x32x16_bf16 v[16:31], v[144:147], v[152:155], v[16:31]
    v_mfma_f32_32x32x16_bf16 v[32:47], v[144:147], v[156:159], v[32:47]
    v_mfma_f32_32x32x16_bf16 v[48:63], v[148:151], v[152:155], v[48:63]
    v_mfma_f32_32x32x16_bf16 v[64:79], v[148:151], v[156:159], v[64:79]
    s_add_u32 s14, s14, 1024
    buffer_load_dwordx4 v[152:155], v5, s[20:23], s41 offen sc1
    buffer_load_dwordx4 v[156:159], v6, s[20:23], s41 offen sc1
    s_add_u32 s41, s41, 1024
    s_waitcnt vmcnt(14) lgkmcnt(12)
    v_mfma_f32_32x32x16_bf16 v[16:31], v[160:163], v[168:171], v[16:31]
    v_mfma_f32_32x32x16_bf16 v[32:47], v[160:163], v[172:175], v[32:47]
    v_mfma_f32_32x32x16_bf16 v[48:63], v[164:167], v[168:171], v[48:63]
    v_mfma_f32_32x32x16_bf16 v[64:79], v[164:167], v[172:175], v[64:79]
    buffer_load_dwordx4 v[160:163], v3, s[16:19], s14 offen sc1
    buffer_load_dwordx4 v[164:167], v4, s[16:19], s14 offen sc1
    s_add_u32 s14, s14, 1024
    buffer_load_dwordx4 v[168:171], v5, s[20:23], s41 offen sc1
    buffer_load_dwordx4 v[172:175], v6, s[20:23], s41 offen sc1
    s_add_u32 s41, s41, 1024
    s_waitcnt vmcnt(16) lgkmcnt(12)
    v_mfma_f32_32x32x16_bf16 v[16:31], v[176:179], v[184:187], v[16:31]
    v_mfma_f32_32x32x16_bf16 v[32:47], v[176:179], v[188:191], v[32:47]
    v_mfma_f32_32x32x16_bf16 v[48:63], v[180:183], v[184:187], v[48:63]
    v_mfma_f32_32x32x16_bf16 v[64:79], v[180:183], v[188:191], v[64:79]
    buffer_load_dwordx4 v[176:179], v3, s[16:19], s14 offen sc1
    buffer_load_dwordx4 v[180:183], v4, s[16:19], s14 offen sc1
    s_add_u32 s14, s14, 1024
    buffer_load_dwordx4 v[184:187], v5, s[20:23], s41 offen sc1
    buffer_load_dwordx4 v[188:191], v6, s[20:23], s41 offen sc1
    s_add_u32 s41, s41, 1024
    s_waitcnt vmcnt(18) lgkmcnt(8)
    v_mfma_f32_32x32x16_bf16 v[16:31], v[192:195], v[200:203], v[16:31]
    v_mfma_f32_32x32x16_bf16 v[32:47], v[192:195], v[204:207], v[32:47]
    v_mfma_f32_32x32x16_bf16 v[48:63], v[196:199], v[200:203], v[48:63]
    v_mfma_f32_32x32x16_bf16 v[64:79], v[196:199], v[204:207], v[64:79]
    buffer_load_dwordx4 v[192:195], v3, s[16:19], s14 offen sc1
    buffer_load_dwordx4 v[196:199], v4, s[16:19], s14 offen sc1
    s_add_u32 s14, s14, 1024
    buffer_load_dwordx4 v[200:203], v5, s[20:23], s41 offen sc1
    buffer_load_dwordx4 v[204:207], v6, s[20:23], s41 offen sc1
    s_add_u32 s41, s41, 1024
    s_waitcnt vmcnt(20) lgkmcnt(4)
    v_mfma_f32_32x32x16_bf16 v[16:31], v[80:83], v[88:91], v[16:31]
    v_mfma_f32_32x32x16_bf16 v[32:47], v[80:83], v[92:95], v[32:47]
    v_mfma_f32_32x32x16_bf16 v[48:63], v[84:87], v[88:91], v[48:63]
    v_mfma_f32_32x32x16_bf16 v[64:79], v[84:87], v[92:95], v[64:79]
    buffer_load_dwordx4 v[80:83], v3, s[16:19], s14 offen sc1
    buffer_load_dwordx4 v[84:87], v4, s[16:19], s14 offen sc1
    s_add_u32 s14, s14, 1024
    buffer_load_dwordx4 v[88:91], v5, s[20:23], s41 offen sc1
    buffer_load_dwordx4 v[92:95], v6, s[20:23], s41 offen sc1
    s_add_u32 s41, s41, 1024
    s_waitcnt vmcnt(22) lgkmcnt(0)
    v_mfma_f32_32x32x16_bf16 v[16:31], v[96:99], v[104:107], v[16:31]
    v_mfma_f32_32x32x16_bf16 v[32:47], v[96:99], v[108:111], v[32:47]
    v_mfma_f32_32x32x16_bf16 v[48:63], v[100:103], v[104:107], v[48:63]
    v_mfma_f32_32x32x16_bf16 v[64:79], v[100:103], v[108:111], v[64:79]
    buffer_load_dwordx4 v[96:99], v3, s[16:19], s14 offen sc1
    buffer_load_dwordx4 v[100:103], v4, s[16:19], s14 offen sc1
    s_add_u32 s14, s14, 1024
    buffer_load_dwordx4 v[104:107], v5, s[20:23], s41 offen sc1
    buffer_load_dwordx4 v[108:111], v6, s[20:23], s41 offen sc1
    s_add_u32 s41, s41, 1024
    s_waitcnt vmcnt(24)
    v_mfma_f32_32x32x16_bf16 v[16:31], v[232:235], v[120:123], v[16:31]
    v_mfma_f32_32x32x16_bf16 v[32:47], v[232:235], v[124:127], v[32:47]
    v_mfma_f32_32x32x16_bf16 v[48:63], v[236:239], v[120:123], v[48:63]
    v_mfma_f32_32x32x16_bf16 v[64:79], v[236:239], v[124:127], v[64:79]
    buffer_load_dwordx4 v[112:115], v3, s[16:19], s14 offen sc1
    buffer_load_dwordx4 v[116:119], v4, s[16:19], s14 offen sc1
    s_add_u32 s14, s14, 1024
    buffer_load_dwordx4 v[120:123], v5, s[20:23], s41 offen sc1
    buffer_load_dwordx4 v[124:127], v6, s[20:23], s41 offen sc1
    s_add_u32 s41, s41, 1024
    s_waitcnt vmcnt(26)
    v_mfma_f32_32x32x16_bf16 v[16:31], v[240:243], v[136:139], v[16:31]
    v_mfma_f32_32x32x16_bf16 v[32:47], v[240:243], v[140:143], v[32:47]
    v_mfma_f32_32x32x16_bf16 v[48:63], v[244:247], v[136:139], v[48:63]
    v_mfma_f32_32x32x16_bf16 v[64:79], v[244:247], v[140:143], v[64:79]
    buffer_load_dwordx4 v[128:131], v3, s[16:19], s14 offen sc1
    buffer_load_dwordx4 v[132:135], v4, s[16:19], s14 offen sc1
    s_add_u32 s14, s14, 1024
    buffer_load_dwordx4 v[136:139], v5, s[20:23], s41 offen sc1
    buffer_load_dwordx4 v[140:143], v6, s[20:23], s41 offen sc1
    s_add_u32 s41, s41, 1024
    s_waitcnt vmcnt(28)
    v_mfma_f32_32x32x16_bf16 v[16:31], v[248:251], v[152:155], v[16:31]
    v_mfma_f32_32x32x16_bf16 v[32:47], v[248:251], v[156:159], v[32:47]
    v_mfma_f32_32x32x16_bf16 v[48:63], v[252:255], v[152:155], v[48:63]
    v_mfma_f32_32x32x16_bf16 v[64:79], v[252:255], v[156:159], v[64:79]
    s_waitcnt vmcnt(24)
    v_mfma_f32_32x32x16_bf16 v[16:31], v[160:163], v[168:171], v[16:31]
    v_mfma_f32_32x32x16_bf16 v[32:47], v[160:163], v[172:175], v[32:47]
    v_mfma_f32_32x32x16_bf16 v[48:63], v[164:167], v[168:171], v[48:63]
    v_mfma_f32_32x32x16_bf16 v[64:79], v[164:167], v[172:175], v[64:79]
    s_waitcnt vmcnt(20)
    v_mfma_f32_32x32x16_bf16 v[16:31], v[176:179], v[184:187], v[16:31]
    v_mfma_f32_32x32x16_bf16 v[32:47], v[176:179], v[188:191], v[32:47]
    v_mfma_f32_32x32x16_bf16 v[48:63], v[180:183], v[184:187], v[48:63]
    v_mfma_f32_32x32x16_bf16 v[64:79], v[180:183], v[188:191], v[64:79]
    s_waitcnt vmcnt(16)
    v_mfma_f32_32x32x16_bf16 v[16:31], v[192:195], v[200:203], v[16:31]
    v_mfma_f32_32x32x16_bf16 v[32:47], v[192:195], v[204:207], v[32:47]
    v_mfma_f32_32x32x16_bf16 v[48:63], v[196:199], v[200:203], v[48:63]
    v_mfma_f32_32x32x16_bf16 v[64:79], v[196:199], v[204:207], v[64:79]
    s_waitcnt vmcnt(12)
    v_mfma_f32_32x32x16_bf16 v[16:31], v[80:83], v[88:91], v[16:31]
    v_mfma_f32_32x32x16_bf16 v[32:47], v[80:83], v[92:95], v[32:47]
    v_mfma_f32_32x32x16_bf16 v[48:63], v[84:87], v[88:91], v[48:63]
    v_mfma_f32_32x32x16_bf16 v[64:79], v[84:87], v[92:95], v[64:79]
    s_waitcnt vmcnt(8)
    v_mfma_f32_32x32x16_bf16 v[16:31], v[96:99], v[104:107], v[16:31]
    v_mfma_f32_32x32x16_bf16 v[32:47], v[96:99], v[108:111], v[32:47]
    v_mfma_f32_32x32x16_bf16 v[48:63], v[100:103], v[104:107], v[48:63]
    v_mfma_f32_32x32x16_bf16 v[64:79], v[100:103], v[108:111], v[64:79]
    s_waitcnt vmcnt(4)
    v_mfma_f32_32x32x16_bf16 v[16:31], v[112:115], v[120:123], v[16:31]
    v_mfma_f32_32x32x16_bf16 v[32:47], v[112:115], v[124:127], v[32:47]
    v_mfma_f32_32x32x16_bf16 v[48:63], v[116:119], v[120:123], v[48:63]
    v_mfma_f32_32x32x16_bf16 v[64:79], v[116:119], v[124:127], v[64:79]
    s_waitcnt vmcnt(0)
    v_mfma_f32_32x32x16_bf16 v[16:31], v[128:131], v[136:139], v[16:31]
    v_mfma_f32_32x32x16_bf16 v[32:47], v[128:131], v[140:143], v[32:47]
    v_mfma_f32_32x32x16_bf16 v[48:63], v[132:135], v[136:139], v[48:63]
    v_mfma_f32_32x32x16_bf16 v[64:79], v[132:135], v[140:143], v[64:79]
    s_mul_i32 s39, s3, 12288
    v_add_u32 v11, s39, v2
    s_sub_u32 s39, s3, 1
    s_and_b32 s39, s39, 3
    s_add_u32 s39, s39, 0
    s_lshl_b32 s39, s39, 12
    v_add_u32 v12, s39, v2
    s_sub_u32 s39, s3, 2
    s_and_b32 s39, s39, 3
    s_add_u32 s39, s39, 3
    s_lshl_b32 s39, s39, 12
    v_add_u32 v13, s39, v2
    s_sub_u32 s39, s3, 3
    s_and_b32 s39, s39, 3
    s_add_u32 s39, s39, 6
    s_lshl_b32 s39, s39, 12
    v_add_u32 v14, s39, v2
    s_sub_u32 s39, s3, 4
    s_and_b32 s39, s39, 3
    s_add_u32 s39, s39, 9
    s_lshl_b32 s39, s39, 12
    v_add_u32 v15, s39, v2
    s_cmp_eq_u32 s3, 0
    s_cbranch_scc1 PD_SKIP0
    ds_write_b128 v12, v[16:19] offset:0
    ds_write_b128 v12, v[20:23] offset:1024
    ds_write_b128 v12, v[24:27] offset:2048
    ds_write_b128 v12, v[28:31] offset:3072
PD_SKIP0:
    s_cmp_eq_u32 s3, 1
    s_cbranch_scc1 PD_SKIP1
    ds_write_b128 v13, v[32:35] offset:0
    ds_write_b128 v13, v[36:39] offset:1024
    ds_write_b128 v13, v[40:43] offset:2048
    ds_write_b128 v13, v[44:47] offset:3072
PD_SKIP1:
    s_cmp_eq_u32 s3, 2
    s_cbranch_scc1 PD_SKIP2
    ds_write_b128 v14, v[48:51] offset:0
    ds_write_b128 v14, v[52:55] offset:1024
    ds_write_b128 v14, v[56:59] offset:2048
    ds_write_b128 v14, v[60:63] offset:3072
PD_SKIP2:
    s_cmp_eq_u32 s3, 3
    s_cbranch_scc1 PD_SKIP3
    ds_write_b128 v15, v[64:67] offset:0
    ds_write_b128 v15, v[68:71] offset:1024
    ds_write_b128 v15, v[72:75] offset:2048
    ds_write_b128 v15, v[76:79] offset:3072
PD_SKIP3:
    s_cmp_eq_u32 s3, 0
    s_cbranch_scc0 PD_MV0
    v_mov_b32 v80, v16
    v_mov_b32 v81, v17
    v_mov_b32 v82, v18
    v_mov_b32 v83, v19
    v_mov_b32 v84, v20
    v_mov_b32 v85, v21
    v_mov_b32 v86, v22
    v_mov_b32 v87, v23
    v_mov_b32 v88, v24
    v_mov_b32 v89, v25
    v_mov_b32 v90, v26
    v_mov_b32 v91, v27
    v_mov_b32 v92, v28
    v_mov_b32 v93, v29
    v_mov_b32 v94, v30
    v_mov_b32 v95, v31
PD_MV0:
    s_cmp_eq_u32 s3, 1
    s_cbranch_scc0 PD_MV1
    v_mov_b32 v80, v32
    v_mov_b32 v81, v33
    v_mov_b32 v82, v34
    v_mov_b32 v83, v35
    v_mov_b32 v84, v36
    v_mov_b32 v85, v37
    v_mov_b32 v86, v38
    v_mov_b32 v87, v39
    v_mov_b32 v88, v40
    v_mov_b32 v89, v41
    v_mov_b32 v90, v42
    v_mov_b32 v91, v43
    v_mov_b32 v92, v44
    v_mov_b32 v93, v45
    v_mov_b32 v94, v46
    v_mov_b32 v95, v47
PD_MV1:
    s_cmp_eq_u32 s3, 2
    s_cbranch_scc0 PD_MV2
    v_mov_b32 v80, v48
    v_mov_b32 v81, v49
    v_mov_b32 v82, v50
    v_mov_b32 v83, v51
    v_mov_b32 v84, v52
    v_mov_b32 v85, v53
    v_mov_b32 v86, v54
    v_mov_b32 v87, v55
    v_mov_b32 v88, v56
    v_mov_b32 v89, v57
    v_mov_b32 v90, v58
    v_mov_b32 v91, v59
    v_mov_b32 v92, v60
    v_mov_b32 v93, v61
    v_mov_b32 v94, v62
    v_mov_b32 v95, v63
PD_MV2:
    s_cmp_eq_u32 s3, 3
    s_cbranch_scc0 PD_MV3
    v_mov_b32 v80, v64
    v_mov_b32 v81, v65
    v_mov_b32 v82, v66
    v_mov_b32 v83, v67
    v_mov_b32 v84, v68
    v_mov_b32 v85, v69
    v_mov_b32 v86, v70
    v_mov_b32 v87, v71
    v_mov_b32 v88, v72
    v_mov_b32 v89, v73
    v_mov_b32 v90, v74
    v_mov_b32 v91, v75
    v_mov_b32 v92, v76
    v_mov_b32 v93, v77
    v_mov_b32 v94, v78
    v_mov_b32 v95, v79
PD_MV3:
    s_waitcnt vmcnt(0)
    v_lshlrev_b32 v150, 16, v208
    v_and_b32 v151, 0xffff0000, v208
    v_lshlrev_b32 v152, 16, v209
    v_and_b32 v153, 0xffff0000, v209
    v_lshlrev_b32 v154, 16, v210
    v_and_b32 v155, 0xffff0000, v210
    v_lshlrev_b32 v156, 16, v211
    v_and_b32 v157, 0xffff0000, v211
    v_lshlrev_b32 v158, 16, v212
    v_and_b32 v159, 0xffff0000, v212
    v_lshlrev_b32 v160, 16, v213
    v_and_b32 v161, 0xffff0000, v213
    v_lshlrev_b32 v162, 16, v214
    v_and_b32 v163, 0xffff0000, v214
    v_lshlrev_b32 v164, 16, v215
    v_and_b32 v165, 0xffff0000, v215
    s_waitcnt lgkmcnt(0)
    s_barrier
    ds_read_b128 v[96:99], v11 offset:0
    ds_read_b128 v[100:103], v11 offset:1024
    ds_read_b128 v[104:107], v11 offset:2048
    ds_read_b128 v[108:111], v11 offset:3072
    ds_read_b128 v[112:115], v11 offset:4096
    ds_read_b128 v[116:119], v11 offset:5120
    ds_read_b128 v[120:123], v11 offset:6144
    ds_read_b128 v[124:127], v11 offset:7168
    ds_read_b128 v[128:131], v11 offset:8192
    ds_read_b128 v[132:135], v11 offset:9216
    ds_read_b128 v[136:139], v11 offset:10240
    ds_read_b128 v[140:143], v11 offset:11264
    s_waitcnt lgkmcnt(8)
    v_add_f32 v80, v80, v96
    v_add_f32 v81, v81, v97
    v_add_f32 v82, v82, v98
    v_add_f32 v83, v83, v99
    v_add_f32 v84, v84, v100
    v_add_f32 v85, v85, v101
    v_add_f32 v86, v86, v102
    v_add_f32 v87, v87, v103
    v_add_f32 v88, v88, v104
    v_add_f32 v89, v89, v105
    v_add_f32 v90, v90, v106
    v_add_f32 v91, v91, v107
    v_add_f32 v92, v92, v108
    v_add_f32 v93, v93, v109
    v_add_f32 v94, v94, v110
    v_add_f32 v95, v95, v111
    s_waitcnt lgkmcnt(4)
    v_add_f32 v80, v80, v112
    v_add_f32 v81, v81, v113
    v_add_f32 v82, v82, v114
    v_add_f32 v83, v83, v115
    v_add_f32 v84, v84, v116
    v_add_f32 v85, v85, v117
    v_add_f32 v86, v86, v118
    v_add_f32 v87, v87, v119
    v_add_f32 v88, v88, v120
    v_add_f32 v89, v89, v121
    v_add_f32 v90, v90, v122
    v_add_f32 v91, v91, v123
    v_add_f32 v92, v92, v124
    v_add_f32 v93, v93, v125
    v_add_f32 v94, v94, v126
    v_add_f32 v95, v95, v127
    s_waitcnt lgkmcnt(0)
    v_add_f32 v80, v80, v128
    v_add_f32 v81, v81, v129
    v_add_f32 v82, v82, v130
    v_add_f32 v83, v83, v131
    v_add_f32 v84, v84, v132
    v_add_f32 v85, v85, v133
    v_add_f32 v86, v86, v134
    v_add_f32 v87, v87, v135
    v_add_f32 v88, v88, v136
    v_add_f32 v89, v89, v137
    v_add_f32 v90, v90, v138
    v_add_f32 v91, v91, v139
    v_add_f32 v92, v92, v140
    v_add_f32 v93, v93, v141
    v_add_f32 v94, v94, v142
    v_add_f32 v95, v95, v143
    s_lshl_b32 s39, s36, 5
    v_add_u32 v13, s39, v7
    v_and_b32 v14, 7, v13
    s_lshl_b32 s39, s15, 2
    v_xor_b32 v14, s39, v14
    v_lshlrev_b32 v13, 7, v13
    v_lshl_add_u32 v13, v8, 3, v13
    v_add_u32 v13, 49152, v13
    v_fma_f32 v150, v80, v216, v150
    v_fma_f32 v151, v81, v217, v151
    v_fma_f32 v152, v82, v218, v152
    v_fma_f32 v153, v83, v219, v153
    v_cvt_pk_bf16_f32 v170, v150, v151
    v_cvt_pk_bf16_f32 v171, v152, v153
    v_xor_b32 v15, 0, v14
    v_lshl_add_u32 v15, v15, 4, v13
    ds_write_b64 v15, v[170:171]
    v_fma_f32 v154, v84, v220, v154
    v_fma_f32 v155, v85, v221, v155
    v_fma_f32 v156, v86, v222, v156
    v_fma_f32 v157, v87, v223, v157
    v_cvt_pk_bf16_f32 v172, v154, v155
    v_cvt_pk_bf16_f32 v173, v156, v157
    v_xor_b32 v15, 1, v14
    v_lshl_add_u32 v15, v15, 4, v13
    ds_write_b64 v15, v[172:173]
    v_fma_f32 v158, v88, v224, v158
    v_fma_f32 v159, v89, v225, v159
    v_fma_f32 v160, v90, v226, v160
    v_fma_f32 v161, v91, v227, v161
    v_cvt_pk_bf16_f32 v174, v158, v159
    v_cvt_pk_bf16_f32 v175, v160, v161
    v_xor_b32 v15, 2, v14
    v_lshl_add_u32 v15, v15, 4, v13
    ds_write_b64 v15, v[174:175]
    v_fma_f32 v162, v92, v228, v162
    v_fma_f32 v163, v93, v229, v163
    v_fma_f32 v164, v94, v230, v164
    v_fma_f32 v165, v95, v231, v165
    v_cvt_pk_bf16_f32 v176, v162, v163
    v_cvt_pk_bf16_f32 v177, v164, v165
    v_xor_b32 v15, 3, v14
    v_lshl_add_u32 v15, v15, 4, v13
    ds_write_b64 v15, v[176:177]
    v_lshrrev_b32 v13, 3, v0
    s_lshl_b32 s39, s3, 4
    v_add_u32 v13, s39, v13
    v_and_b32 v14, 7, v0
    v_and_b32 v15, 7, v13
    v_xor_b32 v15, v14, v15
    v_lshlrev_b32 v15, 4, v15
    v_lshl_add_u32 v15, v13, 7, v15
    v_add_u32 v15, 49152, v15
    s_lshl_b32 s39, s11, 6
    v_add_u32 v13, s39, v13
    v_lshlrev_b32 v13, 10, v13
    v_lshl_add_u32 v13, v14, 4, v13
    s_lshl_b32 s39, s12, 7
    s_add_u32 s40, s39, 8192
    s_waitcnt lgkmcnt(0)
    s_barrier
    ds_read_b128 v[80:83], v15
    ds_read_b128 v[84:87], v15 offset:1024
    s_waitcnt lgkmcnt(0)
    buffer_store_dwordx4 v[80:83], v13, s[28:31], s39 offen
    buffer_store_dwordx4 v[84:87], v13, s[28:31], s40 offen
    s_branch PD_END
PD_IDLE:
    s_cmp_lg_u32 s3, 7
    s_cbranch_scc1 SYN9
    s_mov_b32 s69, 200000
    s_and_b32 s68, s2, 31
    s_lshl_b32 s68, s68, 7
    s_add_u32 s68, s68, 0x1000
    s_mov_b64 exec, 1
POL9:
    buffer_load_dword v253, off, s[64:67], s68 sc1
    s_waitcnt vmcnt(0)
    v_cmp_gt_u32 vcc, 8, v253
    s_cmp_eq_u64 vcc, 0
    s_cbranch_scc1 GOT9
    s_sub_u32 s69, s69, 1
    s_cbranch_scc0 POL9
GOT9:
    s_mov_b64 exec, -1
SYN9:
    s_barrier
    s_barrier
    s_barrier
PD_END:
F_END:
    s_endpgm
CODE_END:

.section .rodata,"a"
.p2align 6
.amdhsa_kernel adaLN_cond__ssm_conv_h3__dense_activation_relu__prompt_kernel
  .amdhsa_next_free_vgpr 256
  .amdhsa_next_free_sgpr 102
  .amdhsa_accum_offset 256
  .amdhsa_group_segment_fixed_size 0
  .amdhsa_kernarg_size 112
  .amdhsa_user_sgpr_count 2
  .amdhsa_user_sgpr_kernarg_segment_ptr 1
  .amdhsa_system_sgpr_workgroup_id_x 1
  .amdhsa_float_denorm_mode_32 3
  .amdhsa_float_denorm_mode_16_64 3
.end_amdhsa_kernel
.text
```
